```python
import torch

def _softmax(x, axis=-1):
    return torch.softmax(x, dim=axis)
def _gelu(x):
    return torch.nn.functional.gelu(x, approximate="tanh")
def _silu(x):
    return torch.nn.functional.silu(x)
def _sigmoid(x):
    return torch.sigmoid(x)
def _layernorm(x, axis=-1, eps=1e-5):
    m = x.mean(dim=axis, keepdim=True)
    v = x.var(dim=axis, keepdim=True, unbiased=False)
    return (x - m) / torch.sqrt(v + eps)
def _scatter_add(tgt, idx, src, axis=0):
    return tgt.clone().index_add_(axis, idx, src)
def _segment_sum(src, seg, n):
    out = torch.zeros((n,) + src.shape[1:], dtype=src.dtype)
    return out.index_add_(0, seg, src)
def _pad(x, pw):
    flat = tuple(v for pair in reversed(pw) for v in pair)
    return torch.nn.functional.pad(x, flat)

kernel_name = 'standalone__linear_kernel_rfa__decode'

def setup_inputs():

    _w = (lambda a: (lambda t: t.to(torch.bfloat16) if t.is_floating_point() else t)(torch.as_tensor(a)))
    B, H, Sq, Sk, D, M = 2, 32, 1, 4096, 128, 64
    return {
        "q": _w((lambda *s: torch.randn(*s, dtype=torch.bfloat16) * 0.4)(B, H, Sq, D)),
        "k": _w((lambda *s: torch.randn(*s, dtype=torch.bfloat16) * 1.6)(B, H, Sk, D)),
        "v": _w((lambda *s: torch.randn(*s, dtype=torch.bfloat16) * 1.6)(B, H, Sk, D)),
        "omega": _w((lambda *s: torch.randn(*s, dtype=torch.bfloat16) * 1.6)(M, D)),
    }

def reference(q, k, v, omega):
    d = q.shape[-1]
    m = omega.shape[0]
    scale = float(d) ** -0.25
    qs = q * scale
    ks = k * scale
    q_proj = torch.einsum("bhsd,md->bhsm", qs, omega)
    k_proj = torch.einsum("bhsd,md->bhsm", ks, omega)
    q_sq = 0.5 * torch.einsum("bhsd,bhsd->bhs", qs, qs)[..., None]
    k_sq = 0.5 * torch.einsum("bhsd,bhsd->bhs", ks, ks)[..., None]
    inv_sqrt_m = float(m) ** -0.5
    phi_q = torch.exp(q_proj - q_sq) * inv_sqrt_m + 1e-6
    phi_k = torch.exp(k_proj - k_sq) * inv_sqrt_m + 1e-6
    kv = torch.einsum("bhsm,bhsd->bhmd", phi_k, v)
    z  = torch.einsum("bhsm->bhm", phi_k)
    num = torch.einsum("bhqm,bhmd->bhqd", phi_q, kv)
    den = torch.einsum("bhqm,bhm->bhq", phi_q, z)[..., None] + 1e-6
    return num / den
```

```asm
; @launch grid=(256,1,1) block=(320,1,1) lds=160576
.amdgcn_target "amdgcn-amd-amdhsa--gfx950"
.text
.globl standalone__linear_kernel_rfa__decode_kernel
.p2align 8
.type standalone__linear_kernel_rfa__decode_kernel,@function
standalone__linear_kernel_rfa__decode_kernel:
  s_cmp_ge_u32 s2, 256
  s_cbranch_scc1 L_end
  s_load_dwordx8 s[4:11], s[0:1], 0
  v_lshrrev_b32 v2, 4, v0
  v_cmp_le_u32 vcc, 16, v2
  s_cbranch_vccnz L_hop1
  v_cmp_le_u32 vcc, 12, v2
  s_cbranch_vccnz L_hop2
  v_cmp_le_u32 vcc, 8, v2
  s_cbranch_vccnz L_hop3
  v_cmp_gt_u32 vcc, 4, v2
  s_cbranch_vccnz L_ldr
  s_lshr_b32 s3, s2, 3
  s_cmp_ge_u32 s3, 17
  s_cbranch_scc1 L_xhop12
  s_cmp_lt_u32 s3, 9
  s_cselect_b32 s20, 12, -5
  s_add_u32 s3, s3, s20
  s_lshl_b32 s3, s3, 9
  s_addk_i32 s3, -88
  s_getpc_b64 s[20:21]
L_pc:
  s_add_u32 s20, s20, s3
  s_addc_u32 s21, s21, 0
  s_setpc_b64 s[20:21]
L_bar1:
  s_barrier
  s_branch L_hop12
L_ldr:
  s_load_dwordx2 s[16:17], s[0:1], 48
  s_load_dwordx4 s[12:15], s[0:1], 32
  s_setprio 3
  v_and_b32 v1, 15, v0
  v_xor_b32 v3, v1, v2
  v_lshlrev_b32 v4, 12, v2
  v_lshl_add_u32 v11, v3, 4, v4
  s_and_b32 s18, s2, 63
  s_lshr_b32 s19, s2, 6
  s_lshl_b32 s32, s18, 6
  s_add_u32 s32, s32, s19
  s_lshl_b32 s51, s18, 1
  s_lshr_b32 s51, 0x11114444, s51
  s_and_b32 s51, s51, 3
  s_lshl4_add_u32 s32, s32, s51
  s_lshl_b32 s32, s32, 10
  s_mov_b32 s49, 0x80800
  s_lshl_b32 s37, s18, 8
  v_lshl_add_u32 v19, v0, 2, s37
  s_movk_i32 s36, 0x900
  s_movk_i32 s37, 0x400
  v_add_u32 v8, s36, v11
  v_xor_b32 v9, 0x640, v11
  v_xor_b32 v10, 0x380, v11
  v_xor_b32 v11, 0xc0, v11
  v_mov_b32 v16, 160512
  v_mov_b32 v17, 0
  v_lshl_add_u32 v18, v1, 2, v16
  ds_write_b32 v18, v17
  s_mov_b32 s22, 0x4000900
  s_mov_b32 s23, 0x20000
  s_movk_i32 s30, 0x4900
  s_mov_b32 s31, 0x20000
  s_mov_b32 m0, 0
  s_waitcnt lgkmcnt(0)
  s_sub_u32 s20, s6, s36
  s_subb_u32 s21, s7, 0
  s_and_b32 s21, s21, 0xffff
  buffer_load_dwordx4 v8, s[20:23], s32 offen offset:0 nt lds
  buffer_load_dwordx4 v9, s[20:23], s32 offen offset:1024 nt lds
  buffer_load_dwordx4 v10, s[20:23], s32 offen offset:2048 nt lds
  buffer_load_dwordx4 v11, s[20:23], s32 offen offset:3072 nt lds
  s_addk_i32 m0, 4096
  s_xor_b32 s32, s32, s49
  s_mov_b32 s50, 0x80c00
  buffer_load_dwordx4 v8, s[20:23], s32 offen offset:0 nt lds
  buffer_load_dwordx4 v9, s[20:23], s32 offen offset:1024 nt lds
  buffer_load_dwordx4 v10, s[20:23], s32 offen offset:2048 nt lds
  buffer_load_dwordx4 v11, s[20:23], s32 offen offset:3072 nt lds
  s_mov_b32 m0, 131072
  s_sub_u32 s28, s10, s36
  s_subb_u32 s29, s11, 0
  s_and_b32 s29, s29, 0xffff
  buffer_load_dwordx4 v8, s[28:31], 0 offen offset:0  lds
  buffer_load_dwordx4 v9, s[28:31], 0 offen offset:1024  lds
  buffer_load_dwordx4 v10, s[28:31], 0 offen offset:2048  lds
  buffer_load_dwordx4 v11, s[28:31], 0 offen offset:3072  lds
  s_addk_i32 m0, 4096
  s_nop 0
  buffer_load_dwordx4 v8, s[28:31], s37 offen offset:0  lds
  buffer_load_dwordx4 v9, s[28:31], s37 offen offset:1024  lds
  buffer_load_dwordx4 v10, s[28:31], s37 offen offset:2048  lds
  buffer_load_dwordx4 v11, s[28:31], s37 offen offset:3072  lds
  s_barrier
  s_branch L_sk1
L_hop1:
  s_and_b32 s18, s2, 63
  s_waitcnt lgkmcnt(0)
  s_lshl_b32 s39, s18, 20
  s_load_dword s38, s[8:9], s39
  s_barrier
  s_branch L_hop15
L_sk1:
  s_addk_i32 m0, 4096
  s_addk_i32 s37, 0x400
  buffer_load_dwordx4 v8, s[28:31], s37 offen offset:0  lds
  buffer_load_dwordx4 v9, s[28:31], s37 offen offset:1024  lds
  buffer_load_dwordx4 v10, s[28:31], s37 offen offset:2048  lds
  buffer_load_dwordx4 v11, s[28:31], s37 offen offset:3072  lds
  s_addk_i32 m0, 4096
  s_addk_i32 s37, 0x400
  buffer_load_dwordx4 v8, s[28:31], s37 offen offset:0  lds
  buffer_load_dwordx4 v9, s[28:31], s37 offen offset:1024  lds
  buffer_load_dwordx4 v10, s[28:31], s37 offen offset:2048  lds
  buffer_load_dwordx4 v11, s[28:31], s37 offen offset:3072  lds
  s_addk_i32 m0, 4096
  s_nop 0
  global_load_lds_dword v19, s[4:5]
  s_movk_i32 m0, 8192
  s_xor_b32 s32, s32, s50
  buffer_load_dwordx4 v8, s[20:23], s32 offen offset:0 nt lds
  buffer_load_dwordx4 v9, s[20:23], s32 offen offset:1024 nt lds
  buffer_load_dwordx4 v10, s[20:23], s32 offen offset:2048 nt lds
  buffer_load_dwordx4 v11, s[20:23], s32 offen offset:3072 nt lds
  s_addk_i32 m0, 4096
  s_xor_b32 s32, s32, s49
  s_mov_b32 s51, 0x80400
  buffer_load_dwordx4 v8, s[20:23], s32 offen offset:0 nt lds
  buffer_load_dwordx4 v9, s[20:23], s32 offen offset:1024 nt lds
  buffer_load_dwordx4 v10, s[20:23], s32 offen offset:2048 nt lds
  buffer_load_dwordx4 v11, s[20:23], s32 offen offset:3072 nt lds
  s_addk_i32 m0, 4096
  s_xor_b32 s32, s32, s51
  buffer_load_dwordx4 v8, s[20:23], s32 offen offset:0 nt lds
  buffer_load_dwordx4 v9, s[20:23], s32 offen offset:1024 nt lds
  buffer_load_dwordx4 v10, s[20:23], s32 offen offset:2048 nt lds
  buffer_load_dwordx4 v11, s[20:23], s32 offen offset:3072 nt lds
  s_addk_i32 m0, 4096
  s_xor_b32 s32, s32, s49
  buffer_load_dwordx4 v8, s[20:23], s32 offen offset:0 nt lds
  buffer_load_dwordx4 v9, s[20:23], s32 offen offset:1024 nt lds
  buffer_load_dwordx4 v10, s[20:23], s32 offen offset:2048 nt lds
  buffer_load_dwordx4 v11, s[20:23], s32 offen offset:3072 nt lds
  s_sub_u32 s24, s8, s36
  s_subb_u32 s25, s9, 0
  s_and_b32 s25, s25, 0xffff
  v_lshlrev_b32 v3, 1, v2
  v_xor_b32 v3, v1, v3
  v_lshl_add_u32 v15, v3, 4, v4
  v_add_u32 v12, s36, v15
  v_xor_b32 v13, 0x680, v15
  v_add_u32 v14, 0x300, v15
  v_xor_b32 v15, 0x80, v15
  v_and_b32 v18, 3, v0
  v_lshl_add_u32 v18, v18, 2, v16
  v_mov_b32 v19, 0
  s_lshl2_add_u32 s33, s18, s19
  s_lshl_b32 s33, s33, 11
  v_mad_u32_u24 v24, v0, 12, s33
  v_lshlrev_b32 v21, 2, s18
  s_mov_b32 s34, -5
  s_mov_b32 s58, 0x100000
  s_mov_b32 s40, 9
  s_getreg_b32 s41, hwreg(HW_REG_XCC_ID, 0, 4)
  s_lshl_b32 s38, s41, 3
  s_mov_b32 s52, 0xff
  s_mov_b32 s53, 0x0
  s_lshr_b64 s[52:53], s[52:53], s38
  s_mov_b32 s54, 0xfdddd500
  s_mov_b32 s55, 0xfdddfdd5
  s_lshr_b64 s[54:55], s[54:55], s38
  s_waitcnt vmcnt(37)
  s_addk_i32 m0, 4096
  s_xor_b32 s32, s32, s50
  buffer_load_dwordx4 v8, s[20:23], s32 offen offset:0 nt lds
  buffer_load_dwordx4 v9, s[20:23], s32 offen offset:1024 nt lds
  buffer_load_dwordx4 v10, s[20:23], s32 offen offset:2048 nt lds
  buffer_load_dwordx4 v11, s[20:23], s32 offen offset:3072 nt lds
  s_waitcnt vmcnt(37)
  s_addk_i32 m0, 4096
  s_xor_b32 s32, s32, s49
  s_branch L_sk2
L_hop2:
  s_barrier
  s_branch L_hop14
L_sk2:
  buffer_load_dwordx4 v8, s[20:23], s32 offen offset:0 nt lds
  buffer_load_dwordx4 v9, s[20:23], s32 offen offset:1024 nt lds
  buffer_load_dwordx4 v10, s[20:23], s32 offen offset:2048 nt lds
  buffer_load_dwordx4 v11, s[20:23], s32 offen offset:3072 nt lds
  s_addk_i32 m0, 4096
  s_xor_b32 s32, s32, s51
  s_add_u32 s32, s32, 0x10000
  s_waitcnt vmcnt(24)
  v_mov_b32 v17, 6
  ds_write_b32 v16, v17
  s_waitcnt vmcnt(20)
L_ld:
  s_waitcnt lgkmcnt(0)
  v_cmp_gt_i32 vcc, s34, v19
  s_cmp_eq_u32 s34, s40
  s_cbranch_vccnz L_retry
  s_cbranch_scc1 L_ev
L_ok:
  s_bitcmp0_b32 s54, 0
  s_cbranch_scc1 L_w1
  s_waitcnt vmcnt(20)
L_w1:
  s_waitcnt vmcnt(21)
  buffer_load_dwordx4 v8, s[20:23], s32 offen offset:0 nt lds
  buffer_load_dwordx4 v9, s[20:23], s32 offen offset:1024 nt lds
  s_bitcmp1_b32 s52, 0
  s_cbranch_scc1 L_w2
  s_waitcnt vmcnt(21)
L_w2:
  buffer_load_dwordx4 v10, s[20:23], s32 offen offset:2048 nt lds
  buffer_load_dwordx4 v11, s[20:23], s32 offen offset:3072 nt lds
  s_addk_i32 m0, 4096
  s_xor_b32 s32, s32, s49
  s_waitcnt vmcnt(20)
  buffer_load_dwordx4 v8, s[20:23], s32 offen offset:0 nt lds
  buffer_load_dwordx4 v9, s[20:23], s32 offen offset:1024 nt lds
  v_add_u32 v17, 2, v17
  ds_write_b32 v16, v17
  s_bitcmp1_b32 s52, 1
  s_cbranch_scc1 L_w3
  s_waitcnt vmcnt(21)
L_w3:
  buffer_load_dwordx4 v10, s[20:23], s32 offen offset:2048 nt lds
  buffer_load_dwordx4 v11, s[20:23], s32 offen offset:3072 nt lds
  s_addk_i32 m0, 4096
  s_xor_b32 s32, s32, s50
  s_bitcmp0_b32 s54, 2
  s_cbranch_scc1 L_w4
  s_waitcnt vmcnt(20)
L_w4:
  s_waitcnt vmcnt(21)
  buffer_load_dwordx4 v8, s[20:23], s32 offen offset:0 nt lds
  buffer_load_dwordx4 v9, s[20:23], s32 offen offset:1024 nt lds
  s_bitcmp1_b32 s52, 2
  s_cbranch_scc1 L_w5
  s_waitcnt vmcnt(21)
L_w5:
  buffer_load_dwordx4 v10, s[20:23], s32 offen offset:2048 nt lds
  buffer_load_dwordx4 v11, s[20:23], s32 offen offset:3072 nt lds
  s_addk_i32 m0, 4096
  s_xor_b32 s32, s32, s49
  s_bitcmp0_b32 s54, 3
  s_cbranch_scc1 L_w6
  s_waitcnt vmcnt(19)
L_w6:
  s_waitcnt vmcnt(20)
  buffer_load_dwordx4 v8, s[20:23], s32 offen offset:0 nt lds
  buffer_load_dwordx4 v9, s[20:23], s32 offen offset:1024 nt lds
  v_add_u32 v17, 2, v17
  ds_write_b32 v16, v17
  s_bitcmp1_b32 s52, 3
  s_cbranch_scc1 L_w7
  s_waitcnt vmcnt(21)
L_w7:
  buffer_load_dwordx4 v10, s[20:23], s32 offen offset:2048 nt lds
  buffer_load_dwordx4 v11, s[20:23], s32 offen offset:3072 nt lds
  ds_read_b32 v19, v18 offset:16
  s_addk_i32 m0, 4096
  s_xor_b32 s32, s32, s51
L_md:
  s_waitcnt lgkmcnt(0)
  v_cmp_ge_i32 vcc, s34, v19
  s_cbranch_vccnz L_retry2
  s_bitcmp0_b32 s54, 4
  s_cbranch_scc1 L_w8
  s_waitcnt vmcnt(20)
L_w8:
  s_waitcnt vmcnt(21)
  buffer_load_dwordx4 v8, s[20:23], s32 offen offset:0 nt lds
  buffer_load_dwordx4 v9, s[20:23], s32 offen offset:1024 nt lds
  s_bitcmp1_b32 s52, 4
  s_cbranch_scc1 L_w9
  s_waitcnt vmcnt(21)
L_w9:
  buffer_load_dwordx4 v10, s[20:23], s32 offen offset:2048 nt lds
  buffer_load_dwordx4 v11, s[20:23], s32 offen offset:3072 nt lds
  s_addk_i32 m0, 4096
  s_xor_b32 s32, s32, s49
  s_bitcmp0_b32 s54, 5
  s_cbranch_scc1 L_w10
  s_waitcnt vmcnt(19)
L_w10:
  s_waitcnt vmcnt(20)
  buffer_load_dwordx4 v8, s[20:23], s32 offen offset:0 nt lds
  buffer_load_dwordx4 v9, s[20:23], s32 offen offset:1024 nt lds
  v_add_u32 v17, 2, v17
  ds_write_b32 v16, v17
  s_branch L_sk3
L_hop3:
  s_barrier
  s_branch L_hop13
L_sk3:
  s_bitcmp1_b32 s52, 5
  s_cbranch_scc1 L_w11
  s_waitcnt vmcnt(21)
L_w11:
  buffer_load_dwordx4 v10, s[20:23], s32 offen offset:2048 nt lds
  buffer_load_dwordx4 v11, s[20:23], s32 offen offset:3072 nt lds
  s_addk_i32 m0, 4096
  s_xor_b32 s32, s32, s50
  s_bitcmp0_b32 s54, 6
  s_cbranch_scc1 L_w12
  s_waitcnt vmcnt(20)
L_w12:
  s_waitcnt vmcnt(21)
  buffer_load_dwordx4 v8, s[20:23], s32 offen offset:0 nt lds
  buffer_load_dwordx4 v9, s[20:23], s32 offen offset:1024 nt lds
  s_bitcmp1_b32 s52, 6
  s_cbranch_scc1 L_w13
  s_waitcnt vmcnt(21)
L_w13:
  buffer_load_dwordx4 v10, s[20:23], s32 offen offset:2048 nt lds
  buffer_load_dwordx4 v11, s[20:23], s32 offen offset:3072 nt lds
  s_addk_i32 m0, 4096
  s_xor_b32 s32, s32, s49
  s_bitcmp0_b32 s54, 7
  s_cbranch_scc1 L_w14
  s_waitcnt vmcnt(19)
L_w14:
  s_waitcnt vmcnt(20)
  buffer_load_dwordx4 v8, s[20:23], s32 offen offset:0 nt lds
  buffer_load_dwordx4 v9, s[20:23], s32 offen offset:1024 nt lds
  v_add_u32 v17, 2, v17
  ds_write_b32 v16, v17
  s_bitcmp1_b32 s52, 7
  s_cbranch_scc1 L_w15
  s_waitcnt vmcnt(21)
L_w15:
  buffer_load_dwordx4 v10, s[20:23], s32 offen offset:2048 nt lds
  buffer_load_dwordx4 v11, s[20:23], s32 offen offset:3072 nt lds
  ds_read_b32 v19, v18 offset:16
  s_addk_i32 m0, 4096
  s_bitset0_b32 m0, 17
  s_xor_b32 s32, s32, s51
  s_add_u32 s32, s32, 0x10000
  s_add_u32 s34, s34, 2
  s_cmp_lg_u32 s34, 21
  s_cbranch_scc1 L_ld
  s_waitcnt vmcnt(20)
L_ldend:
  s_waitcnt lgkmcnt(0)
L_en16:
  v_cmp_gt_i32 vcc, 21, v19
  s_cbranch_vccnz L_rt16
  global_load_dword v20, v21, s[14:15] sc1
  buffer_load_dwordx4 v8, s[20:23], s32 offen offset:0 nt lds
  buffer_load_dwordx4 v9, s[20:23], s32 offen offset:1024 nt lds
  s_waitcnt vmcnt(22)
  buffer_load_dwordx4 v10, s[20:23], s32 offen offset:2048 nt lds
  buffer_load_dwordx4 v11, s[20:23], s32 offen offset:3072 nt lds
  s_addk_i32 m0, 4096
  s_xor_b32 s32, s32, s49
  v_lshrrev_b32 v4, 2, v0
  v_and_b32 v5, 7, v4
  v_lshlrev_b32 v5, 5, v5
  v_lshl_add_u32 v5, v4, 8, v5
  v_and_b32 v4, 3, v0
  v_lshl_add_u32 v32, v4, 3, v5
  v_add_u32 v32, 0x10000, v32
  v_xor_b32 v4, 1, v4
  s_waitcnt vmcnt(21)
  v_add_u32 v17, 2, v17
  ds_write_b32 v16, v17
  buffer_load_dwordx4 v8, s[20:23], s32 offen offset:0 nt lds
  buffer_load_dwordx4 v9, s[20:23], s32 offen offset:1024 nt lds
  s_waitcnt vmcnt(22)
  buffer_load_dwordx4 v10, s[20:23], s32 offen offset:2048 nt lds
  buffer_load_dwordx4 v11, s[20:23], s32 offen offset:3072 nt lds
  s_addk_i32 m0, 4096
  s_xor_b32 s32, s32, s50
  v_lshl_add_u32 v4, v2, 2, v4
  v_mov_b32 v30, 147712
  v_lshl_add_u32 v23, v4, 3, v30
  v_lshl_add_u32 v30, v0, 4, v30
  v_xor_b32 v33, 32, v32
  v_xor_b32 v34, 64, v32
  v_xor_b32 v35, 96, v32
  v_xor_b32 v36, 128, v32
  s_waitcnt vmcnt(21)
  v_add_u32 v17, 1, v17
  ds_write_b32 v16, v17
  buffer_load_dwordx4 v8, s[20:23], s32 offen offset:0 nt lds
  buffer_load_dwordx4 v9, s[20:23], s32 offen offset:1024 nt lds
  s_waitcnt vmcnt(22)
  buffer_load_dwordx4 v10, s[20:23], s32 offen offset:2048 nt lds
  buffer_load_dwordx4 v11, s[20:23], s32 offen offset:3072 nt lds
  s_branch L_sk4
L_hop4:
  s_branch L_tback
L_xhop4:
  s_branch L_bar1
L_sk4:
  s_addk_i32 m0, 4096
  s_xor_b32 s32, s32, s49
  v_xor_b32 v37, 160, v32
  v_xor_b32 v38, 192, v32
  v_xor_b32 v39, 224, v32
  s_mov_b32 s55, 923154365
  s_lshl_b32 s36, s18, 8
  v_lshl_add_u32 v28, v2, 5, v1
  v_lshl_add_u32 v28, v28, 1, s36
  v_xor_b32 v25, 2048, v24
  s_bitcmp0_b32 s54, 3
  s_cbranch_scc1 L_w17
  s_waitcnt vmcnt(20)
L_w17:
  s_waitcnt vmcnt(21)
  v_add_u32 v17, 1, v17
  ds_write_b32 v16, v17
  buffer_load_dwordx4 v8, s[20:23], s32 offen offset:0 nt lds
  buffer_load_dwordx4 v9, s[20:23], s32 offen offset:1024 nt lds
  s_waitcnt vmcnt(22)
  buffer_load_dwordx4 v10, s[20:23], s32 offen offset:2048 nt lds
  buffer_load_dwordx4 v11, s[20:23], s32 offen offset:3072 nt lds
  s_addk_i32 m0, 4096
  s_xor_b32 s32, s32, s51
  v_xor_b32 v26, 4096, v24
  v_xor_b32 v27, 6144, v24
  s_lshl_b64 s[42:43], -1, 16
  s_lshl_b64 s[44:45], -1, 32
  s_lshl_b64 s[46:47], -1, 48
  ds_read_b32 v19, v18 offset:16
  s_waitcnt vmcnt(21)
  v_add_u32 v17, 1, v17
  ds_write_b32 v16, v17
  s_waitcnt lgkmcnt(0)
L_en18:
  v_cmp_gt_i32 vcc, 22, v19
  s_cbranch_vccnz L_rt18
  buffer_load_dwordx4 v8, s[20:23], s32 offen offset:0 nt lds
  buffer_load_dwordx4 v9, s[20:23], s32 offen offset:1024 nt lds
  s_waitcnt vmcnt(22)
  buffer_load_dwordx4 v10, s[20:23], s32 offen offset:2048 nt lds
  buffer_load_dwordx4 v11, s[20:23], s32 offen offset:3072 nt lds
  s_addk_i32 m0, 4096
  s_xor_b32 s32, s32, s49
  s_bitcmp0_b32 s54, 5
  s_cbranch_scc1 L_w19
  s_waitcnt vmcnt(19)
L_w19:
  s_waitcnt vmcnt(20)
  v_add_u32 v17, 1, v17
  ds_write_b32 v16, v17
  buffer_load_dwordx4 v8, s[20:23], s32 offen offset:0 nt lds
  buffer_load_dwordx4 v9, s[20:23], s32 offen offset:1024 nt lds
  s_waitcnt vmcnt(21)
  buffer_load_dwordx4 v10, s[20:23], s32 offen offset:2048 nt lds
  buffer_load_dwordx4 v11, s[20:23], s32 offen offset:3072 nt lds
  s_addk_i32 m0, 4096
  s_xor_b32 s32, s32, s50
  ds_read2_b64 v[96:99], v23 offset0:192 offset1:193
  ds_read_b32 v19, v18 offset:16
  s_waitcnt vmcnt(20)
  buffer_load_dwordx4 v8, s[20:23], s32 offen offset:0 nt lds
  buffer_load_dwordx4 v9, s[20:23], s32 offen offset:1024 nt lds
  s_waitcnt vmcnt(21)
  buffer_load_dwordx4 v10, s[20:23], s32 offen offset:2048 nt lds
  buffer_load_dwordx4 v11, s[20:23], s32 offen offset:3072 nt lds
  s_addk_i32 m0, 4096
  s_xor_b32 s32, s32, s49
  ds_read_b64_tr_b16 v[120:121], v32 offset:0
  ds_read_b64_tr_b16 v[122:123], v33 offset:0
  ds_read_b64_tr_b16 v[124:125], v34 offset:0
  ds_read_b64_tr_b16 v[126:127], v35 offset:0
  ds_read_b64_tr_b16 v[128:129], v36 offset:0
  ds_read_b64_tr_b16 v[130:131], v37 offset:0
  ds_read_b64_tr_b16 v[132:133], v38 offset:0
  ds_read_b64_tr_b16 v[134:135], v39 offset:0
  s_waitcnt lgkmcnt(8)
  ds_read2_b64 v[100:103], v23 offset0:208 offset1:209
  ds_read_b32 v19, v18 offset:16
  s_bitcmp0_b32 s54, 7
  s_cbranch_scc1 L_w20
  s_waitcnt vmcnt(19)
L_w20:
  s_waitcnt vmcnt(20)
  buffer_load_dwordx4 v8, s[20:23], s32 offen offset:0 nt lds
  buffer_load_dwordx4 v9, s[20:23], s32 offen offset:1024 nt lds
  s_branch L_sk5
L_hop5:
  s_branch L_tback
L_xhop5:
  s_branch L_bar1
L_sk5:
  s_waitcnt vmcnt(21)
  buffer_load_dwordx4 v10, s[20:23], s32 offen offset:2048 nt lds
  buffer_load_dwordx4 v11, s[20:23], s32 offen offset:3072 nt lds
  s_addk_i32 m0, 4096
  s_xor_b32 s32, s32, s51
  s_add_u32 s32, s32, 0x10000
  ds_read_b64_tr_b16 v[136:137], v32 offset:4096
  ds_read_b64_tr_b16 v[138:139], v33 offset:4096
  ds_read_b64_tr_b16 v[140:141], v34 offset:4096
  ds_read_b64_tr_b16 v[142:143], v35 offset:4096
  ds_read_b64_tr_b16 v[144:145], v36 offset:4096
  ds_read_b64_tr_b16 v[146:147], v37 offset:4096
  ds_read_b64_tr_b16 v[148:149], v38 offset:4096
  ds_read_b64_tr_b16 v[150:151], v39 offset:4096
  s_waitcnt lgkmcnt(8)
  v_mfma_f32_16x16x32_bf16 v[104:107], v[96:99], v[120:123], 0
  v_mfma_f32_16x16x32_bf16 v[108:111], v[96:99], v[124:127], 0
  v_mfma_f32_16x16x32_bf16 v[112:115], v[96:99], v[128:131], 0
  v_mfma_f32_16x16x32_bf16 v[116:119], v[96:99], v[132:135], 0
  ds_read2_b64 v[96:99], v23 offset0:224 offset1:225
  ds_read_b32 v19, v18 offset:16
  s_waitcnt vmcnt(20)
  s_waitcnt lgkmcnt(0)
L_en21:
  v_cmp_gt_i32 vcc, 23, v19
  s_cbranch_vccnz L_rt21
  buffer_load_dwordx4 v8, s[20:23], s32 offen offset:0 nt lds
  buffer_load_dwordx4 v9, s[20:23], s32 offen offset:1024 nt lds
  s_waitcnt vmcnt(21)
  buffer_load_dwordx4 v10, s[20:23], s32 offen offset:2048 nt lds
  buffer_load_dwordx4 v11, s[20:23], s32 offen offset:3072 nt lds
  s_addk_i32 m0, 4096
  s_xor_b32 s32, s32, s49
  ds_read_b64_tr_b16 v[120:121], v32 offset:8192
  ds_read_b64_tr_b16 v[122:123], v33 offset:8192
  ds_read_b64_tr_b16 v[124:125], v34 offset:8192
  ds_read_b64_tr_b16 v[126:127], v35 offset:8192
  ds_read_b64_tr_b16 v[128:129], v36 offset:8192
  ds_read_b64_tr_b16 v[130:131], v37 offset:8192
  ds_read_b64_tr_b16 v[132:133], v38 offset:8192
  ds_read_b64_tr_b16 v[134:135], v39 offset:8192
  s_waitcnt lgkmcnt(8)
  v_mfma_f32_16x16x32_bf16 v[104:107], v[100:103], v[136:139], v[104:107]
  v_mfma_f32_16x16x32_bf16 v[108:111], v[100:103], v[140:143], v[108:111]
  v_mfma_f32_16x16x32_bf16 v[112:115], v[100:103], v[144:147], v[112:115]
  v_mfma_f32_16x16x32_bf16 v[116:119], v[100:103], v[148:151], v[116:119]
  ds_read2_b64 v[100:103], v23 offset0:240 offset1:241
  ds_read_b32 v19, v18 offset:16
  s_waitcnt vmcnt(20)
  buffer_load_dwordx4 v8, s[20:23], s32 offen offset:0 nt lds
  buffer_load_dwordx4 v9, s[20:23], s32 offen offset:1024 nt lds
  s_waitcnt vmcnt(21)
  buffer_load_dwordx4 v10, s[20:23], s32 offen offset:2048 nt lds
  buffer_load_dwordx4 v11, s[20:23], s32 offen offset:3072 nt lds
  s_addk_i32 m0, 4096
  s_xor_b32 s32, s32, s50
  ds_read_b64_tr_b16 v[136:137], v32 offset:12288
  ds_read_b64_tr_b16 v[138:139], v33 offset:12288
  ds_read_b64_tr_b16 v[140:141], v34 offset:12288
  ds_read_b64_tr_b16 v[142:143], v35 offset:12288
  ds_read_b64_tr_b16 v[144:145], v36 offset:12288
  ds_read_b64_tr_b16 v[146:147], v37 offset:12288
  ds_read_b64_tr_b16 v[148:149], v38 offset:12288
  ds_read_b64_tr_b16 v[150:151], v39 offset:12288
  s_waitcnt lgkmcnt(8)
  v_mfma_f32_16x16x32_bf16 v[104:107], v[96:99], v[120:123], v[104:107]
  v_mfma_f32_16x16x32_bf16 v[108:111], v[96:99], v[124:127], v[108:111]
  v_mfma_f32_16x16x32_bf16 v[112:115], v[96:99], v[128:131], v[112:115]
  v_mfma_f32_16x16x32_bf16 v[116:119], v[96:99], v[132:135], v[116:119]
  ds_read2_b64 v[96:99], v23 offset0:128 offset1:129
  ds_read_b32 v19, v18 offset:16
  s_waitcnt vmcnt(20)
  buffer_load_dwordx4 v8, s[20:23], s32 offen offset:0 nt lds
  s_branch L_sk6
L_xhop6:
  s_branch L_bar1
L_hop6:
  s_branch L_tback
L_sk6:
  buffer_load_dwordx4 v9, s[20:23], s32 offen offset:1024 nt lds
  s_waitcnt vmcnt(21)
  buffer_load_dwordx4 v10, s[20:23], s32 offen offset:2048 nt lds
  buffer_load_dwordx4 v11, s[20:23], s32 offen offset:3072 nt lds
  s_addk_i32 m0, 4096
  s_xor_b32 s32, s32, s49
  ds_read_b64_tr_b16 v[120:121], v32 offset:16384
  ds_read_b64_tr_b16 v[122:123], v33 offset:16384
  ds_read_b64_tr_b16 v[124:125], v34 offset:16384
  ds_read_b64_tr_b16 v[126:127], v35 offset:16384
  ds_read_b64_tr_b16 v[128:129], v36 offset:16384
  ds_read_b64_tr_b16 v[130:131], v37 offset:16384
  ds_read_b64_tr_b16 v[132:133], v38 offset:16384
  ds_read_b64_tr_b16 v[134:135], v39 offset:16384
  s_waitcnt lgkmcnt(8)
  v_mfma_f32_16x16x32_bf16 v[104:107], v[100:103], v[136:139], v[104:107]
  v_mfma_f32_16x16x32_bf16 v[108:111], v[100:103], v[140:143], v[108:111]
  v_mfma_f32_16x16x32_bf16 v[112:115], v[100:103], v[144:147], v[112:115]
  v_mfma_f32_16x16x32_bf16 v[116:119], v[100:103], v[148:151], v[116:119]
  ds_read2_b64 v[100:103], v23 offset0:144 offset1:145
  ds_read_b32 v19, v18 offset:16
  s_bitcmp0_b32 s54, 3
  s_cbranch_scc1 L_w22
  s_waitcnt vmcnt(19)
L_w22:
  s_waitcnt vmcnt(20)
  buffer_load_dwordx4 v8, s[20:23], s32 offen offset:0 nt lds
  buffer_load_dwordx4 v9, s[20:23], s32 offen offset:1024 nt lds
  s_waitcnt vmcnt(21)
  buffer_load_dwordx4 v10, s[20:23], s32 offen offset:2048 nt lds
  buffer_load_dwordx4 v11, s[20:23], s32 offen offset:3072 nt lds
  s_addk_i32 m0, 4096
  s_xor_b32 s32, s32, s51
  ds_read_b64_tr_b16 v[136:137], v32 offset:20480
  ds_read_b64_tr_b16 v[138:139], v33 offset:20480
  ds_read_b64_tr_b16 v[140:141], v34 offset:20480
  ds_read_b64_tr_b16 v[142:143], v35 offset:20480
  ds_read_b64_tr_b16 v[144:145], v36 offset:20480
  ds_read_b64_tr_b16 v[146:147], v37 offset:20480
  ds_read_b64_tr_b16 v[148:149], v38 offset:20480
  ds_read_b64_tr_b16 v[150:151], v39 offset:20480
  s_waitcnt lgkmcnt(8)
  v_mfma_f32_16x16x32_bf16 v[104:107], v[96:99], v[120:123], v[104:107]
  v_mfma_f32_16x16x32_bf16 v[108:111], v[96:99], v[124:127], v[108:111]
  v_mfma_f32_16x16x32_bf16 v[112:115], v[96:99], v[128:131], v[112:115]
  v_mfma_f32_16x16x32_bf16 v[116:119], v[96:99], v[132:135], v[116:119]
  ds_read2_b64 v[96:99], v23 offset0:160 offset1:161
  ds_read_b32 v19, v18 offset:16
  s_waitcnt vmcnt(20)
  s_waitcnt lgkmcnt(0)
L_en23:
  v_cmp_gt_i32 vcc, 24, v19
  s_cbranch_vccnz L_rt23
  buffer_load_dwordx4 v8, s[20:23], s32 offen offset:0 nt lds
  buffer_load_dwordx4 v9, s[20:23], s32 offen offset:1024 nt lds
  buffer_load_dwordx4 v10, s[20:23], s32 offen offset:2048 nt lds
  buffer_load_dwordx4 v11, s[20:23], s32 offen offset:3072 nt lds
  s_addk_i32 m0, 4096
  s_xor_b32 s32, s32, s49
  buffer_load_dwordx4 v8, s[20:23], s32 offen offset:0 nt lds
  buffer_load_dwordx4 v9, s[20:23], s32 offen offset:1024 nt lds
  buffer_load_dwordx4 v10, s[20:23], s32 offen offset:2048 nt lds
  buffer_load_dwordx4 v11, s[20:23], s32 offen offset:3072 nt lds
  s_addk_i32 m0, 4096
  s_xor_b32 s32, s32, s50
  buffer_load_dwordx4 v8, s[20:23], s32 offen offset:0 nt lds
  buffer_load_dwordx4 v9, s[20:23], s32 offen offset:1024 nt lds
  buffer_load_dwordx4 v10, s[20:23], s32 offen offset:2048 nt lds
  buffer_load_dwordx4 v11, s[20:23], s32 offen offset:3072 nt lds
  s_addk_i32 m0, 4096
  s_xor_b32 s32, s32, s49
  buffer_load_dwordx4 v8, s[20:23], s32 offen offset:0 nt lds
  buffer_load_dwordx4 v9, s[20:23], s32 offen offset:1024 nt lds
  buffer_load_dwordx4 v10, s[20:23], s32 offen offset:2048 nt lds
  buffer_load_dwordx4 v11, s[20:23], s32 offen offset:3072 nt lds
  s_branch L_sk7
L_hop7:
  s_branch L_tback
L_xhop7:
  s_branch L_bar1
L_sk7:
  ds_read_b64_tr_b16 v[120:121], v32 offset:24576
  ds_read_b64_tr_b16 v[122:123], v33 offset:24576
  ds_read_b64_tr_b16 v[124:125], v34 offset:24576
  ds_read_b64_tr_b16 v[126:127], v35 offset:24576
  ds_read_b64_tr_b16 v[128:129], v36 offset:24576
  ds_read_b64_tr_b16 v[130:131], v37 offset:24576
  ds_read_b64_tr_b16 v[132:133], v38 offset:24576
  ds_read_b64_tr_b16 v[134:135], v39 offset:24576
  s_waitcnt lgkmcnt(8)
  v_mfma_f32_16x16x32_bf16 v[104:107], v[100:103], v[136:139], v[104:107]
  v_mfma_f32_16x16x32_bf16 v[108:111], v[100:103], v[140:143], v[108:111]
  v_mfma_f32_16x16x32_bf16 v[112:115], v[100:103], v[144:147], v[112:115]
  v_mfma_f32_16x16x32_bf16 v[116:119], v[100:103], v[148:151], v[116:119]
  ds_read2_b64 v[100:103], v23 offset0:176 offset1:177
  ds_read_b32 v19, v18 offset:16
  s_waitcnt vmcnt(32)
  ds_read_b64_tr_b16 v[136:137], v32 offset:28672
  ds_read_b64_tr_b16 v[138:139], v33 offset:28672
  ds_read_b64_tr_b16 v[140:141], v34 offset:28672
  ds_read_b64_tr_b16 v[142:143], v35 offset:28672
  ds_read_b64_tr_b16 v[144:145], v36 offset:28672
  ds_read_b64_tr_b16 v[146:147], v37 offset:28672
  ds_read_b64_tr_b16 v[148:149], v38 offset:28672
  ds_read_b64_tr_b16 v[150:151], v39 offset:28672
  s_waitcnt lgkmcnt(8)
  v_mfma_f32_16x16x32_bf16 v[104:107], v[96:99], v[120:123], v[104:107]
  v_mfma_f32_16x16x32_bf16 v[108:111], v[96:99], v[124:127], v[108:111]
  v_mfma_f32_16x16x32_bf16 v[112:115], v[96:99], v[128:131], v[112:115]
  v_mfma_f32_16x16x32_bf16 v[116:119], v[96:99], v[132:135], v[116:119]
  ds_read2_b64 v[96:99], v23 offset0:64 offset1:65
L_en24:
  v_cmp_gt_i32 vcc, 29, v19
  s_bitcmp1_b32 vcc_lo, 0
  s_cbranch_scc1 L_rt24
  ds_read_b96 v[48:50], v30 offset:8704
  ds_read_b32 v19, v18 offset:16
  s_waitcnt vmcnt(28)
  ds_read_b64_tr_b16 v[120:121], v32 offset:32768
  ds_read_b64_tr_b16 v[122:123], v33 offset:32768
  ds_read_b64_tr_b16 v[124:125], v34 offset:32768
  ds_read_b64_tr_b16 v[126:127], v35 offset:32768
  ds_read_b64_tr_b16 v[128:129], v36 offset:32768
  ds_read_b64_tr_b16 v[130:131], v37 offset:32768
  ds_read_b64_tr_b16 v[132:133], v38 offset:32768
  ds_read_b64_tr_b16 v[134:135], v39 offset:32768
  s_waitcnt lgkmcnt(8)
  v_mfma_f32_16x16x32_bf16 v[104:107], v[100:103], v[136:139], v[104:107]
  v_mfma_f32_16x16x32_bf16 v[108:111], v[100:103], v[140:143], v[108:111]
  v_mfma_f32_16x16x32_bf16 v[112:115], v[100:103], v[144:147], v[112:115]
  v_mfma_f32_16x16x32_bf16 v[116:119], v[100:103], v[148:151], v[116:119]
  ds_read2_b64 v[100:103], v23 offset0:80 offset1:81
L_en25:
  v_cmp_gt_i32 vcc, 29, v19
  s_bitcmp1_b32 vcc_lo, 1
  s_cbranch_scc1 L_rt25
  ds_read_b96 v[52:54], v30 offset:9728
  ds_read_b32 v19, v18 offset:16
  s_waitcnt vmcnt(24)
  ds_read_b64_tr_b16 v[136:137], v32 offset:36864
  ds_read_b64_tr_b16 v[138:139], v33 offset:36864
  ds_read_b64_tr_b16 v[140:141], v34 offset:36864
  ds_read_b64_tr_b16 v[142:143], v35 offset:36864
  ds_read_b64_tr_b16 v[144:145], v36 offset:36864
  ds_read_b64_tr_b16 v[146:147], v37 offset:36864
  ds_read_b64_tr_b16 v[148:149], v38 offset:36864
  ds_read_b64_tr_b16 v[150:151], v39 offset:36864
  s_waitcnt lgkmcnt(8)
  v_mfma_f32_16x16x32_bf16 v[104:107], v[96:99], v[120:123], v[104:107]
  v_mfma_f32_16x16x32_bf16 v[108:111], v[96:99], v[124:127], v[108:111]
  v_mfma_f32_16x16x32_bf16 v[112:115], v[96:99], v[128:131], v[112:115]
  v_mfma_f32_16x16x32_bf16 v[116:119], v[96:99], v[132:135], v[116:119]
  s_branch L_sk8
L_hop8:
  s_branch L_hop4
L_xhop8:
  s_branch L_bar1
L_sk8:
  ds_read2_b64 v[96:99], v23 offset0:96 offset1:97
L_en26:
  v_cmp_gt_i32 vcc, 29, v19
  s_bitcmp1_b32 vcc_lo, 2
  s_cbranch_scc1 L_rt26
  v_add_f32 v48, v48, v52
  v_add_f32 v49, v49, v53
  v_add_f32 v50, v50, v54
  ds_read_b96 v[52:54], v30 offset:10752
  ds_read_b32 v19, v18 offset:16
  s_waitcnt vmcnt(20)
  ds_read_b64_tr_b16 v[120:121], v32 offset:40960
  ds_read_b64_tr_b16 v[122:123], v33 offset:40960
  ds_read_b64_tr_b16 v[124:125], v34 offset:40960
  ds_read_b64_tr_b16 v[126:127], v35 offset:40960
  ds_read_b64_tr_b16 v[128:129], v36 offset:40960
  ds_read_b64_tr_b16 v[130:131], v37 offset:40960
  ds_read_b64_tr_b16 v[132:133], v38 offset:40960
  ds_read_b64_tr_b16 v[134:135], v39 offset:40960
  s_waitcnt lgkmcnt(8)
  v_mfma_f32_16x16x32_bf16 v[104:107], v[100:103], v[136:139], v[104:107]
  v_mfma_f32_16x16x32_bf16 v[108:111], v[100:103], v[140:143], v[108:111]
  v_mfma_f32_16x16x32_bf16 v[112:115], v[100:103], v[144:147], v[112:115]
  v_mfma_f32_16x16x32_bf16 v[116:119], v[100:103], v[148:151], v[116:119]
  ds_read2_b64 v[100:103], v23 offset0:112 offset1:113
L_en27:
  v_cmp_gt_i32 vcc, 29, v19
  s_bitcmp1_b32 vcc_lo, 3
  s_cbranch_scc1 L_rt27
  v_add_f32 v48, v48, v52
  v_add_f32 v49, v49, v53
  v_add_f32 v50, v50, v54
  ds_read_b96 v[52:54], v30 offset:11776
  s_waitcnt vmcnt(16)
  ds_read_b64_tr_b16 v[136:137], v32 offset:45056
  ds_read_b64_tr_b16 v[138:139], v33 offset:45056
  ds_read_b64_tr_b16 v[140:141], v34 offset:45056
  ds_read_b64_tr_b16 v[142:143], v35 offset:45056
  ds_read_b64_tr_b16 v[144:145], v36 offset:45056
  ds_read_b64_tr_b16 v[146:147], v37 offset:45056
  ds_read_b64_tr_b16 v[148:149], v38 offset:45056
  ds_read_b64_tr_b16 v[150:151], v39 offset:45056
  s_waitcnt lgkmcnt(8)
  v_mfma_f32_16x16x32_bf16 v[104:107], v[96:99], v[120:123], v[104:107]
  v_mfma_f32_16x16x32_bf16 v[108:111], v[96:99], v[124:127], v[108:111]
  v_mfma_f32_16x16x32_bf16 v[112:115], v[96:99], v[128:131], v[112:115]
  v_mfma_f32_16x16x32_bf16 v[116:119], v[96:99], v[132:135], v[116:119]
  ds_read2_b64 v[96:99], v23 offset0:0 offset1:1
  v_add_f32 v48, v48, v52
  v_add_f32 v49, v49, v53
  v_add_f32 v50, v50, v54
  s_waitcnt vmcnt(12)
  ds_read_b64_tr_b16 v[120:121], v32 offset:49152
  ds_read_b64_tr_b16 v[122:123], v33 offset:49152
  ds_read_b64_tr_b16 v[124:125], v34 offset:49152
  ds_read_b64_tr_b16 v[126:127], v35 offset:49152
  ds_read_b64_tr_b16 v[128:129], v36 offset:49152
  ds_read_b64_tr_b16 v[130:131], v37 offset:49152
  ds_read_b64_tr_b16 v[132:133], v38 offset:49152
  ds_read_b64_tr_b16 v[134:135], v39 offset:49152
  s_waitcnt lgkmcnt(8)
  v_mfma_f32_16x16x32_bf16 v[104:107], v[100:103], v[136:139], v[104:107]
  v_mfma_f32_16x16x32_bf16 v[108:111], v[100:103], v[140:143], v[108:111]
  v_mfma_f32_16x16x32_bf16 v[112:115], v[100:103], v[144:147], v[112:115]
  v_mfma_f32_16x16x32_bf16 v[116:119], v[100:103], v[148:151], v[116:119]
  ds_read2_b64 v[100:103], v23 offset0:16 offset1:17
  s_waitcnt vmcnt(8)
  ds_read_b64_tr_b16 v[136:137], v32 offset:53248
  ds_read_b64_tr_b16 v[138:139], v33 offset:53248
  ds_read_b64_tr_b16 v[140:141], v34 offset:53248
  ds_read_b64_tr_b16 v[142:143], v35 offset:53248
  ds_read_b64_tr_b16 v[144:145], v36 offset:53248
  ds_read_b64_tr_b16 v[146:147], v37 offset:53248
  ds_read_b64_tr_b16 v[148:149], v38 offset:53248
  ds_read_b64_tr_b16 v[150:151], v39 offset:53248
  s_waitcnt lgkmcnt(8)
  s_branch L_sk9
L_hop9:
  s_branch L_hop5
L_xhop9:
  s_branch L_bar1
L_sk9:
  v_mfma_f32_16x16x32_bf16 v[104:107], v[96:99], v[120:123], v[104:107]
  v_mfma_f32_16x16x32_bf16 v[108:111], v[96:99], v[124:127], v[108:111]
  v_mfma_f32_16x16x32_bf16 v[112:115], v[96:99], v[128:131], v[112:115]
  v_mfma_f32_16x16x32_bf16 v[116:119], v[96:99], v[132:135], v[116:119]
  ds_read2_b64 v[96:99], v23 offset0:32 offset1:33
  v_readfirstlane_b32 s38, v20
  s_nop 0
  s_and_b32 s37, s38, 0x1f1f1f1f
  s_cmp_eq_u32 s37, s39
  s_cselect_b32 s48, -1, 0
  s_waitcnt vmcnt(4)
  ds_read_b64_tr_b16 v[120:121], v32 offset:57344
  ds_read_b64_tr_b16 v[122:123], v33 offset:57344
  ds_read_b64_tr_b16 v[124:125], v34 offset:57344
  ds_read_b64_tr_b16 v[126:127], v35 offset:57344
  ds_read_b64_tr_b16 v[128:129], v36 offset:57344
  ds_read_b64_tr_b16 v[130:131], v37 offset:57344
  ds_read_b64_tr_b16 v[132:133], v38 offset:57344
  ds_read_b64_tr_b16 v[134:135], v39 offset:57344
  global_load_dwordx3 v[72:74], v25, s[16:17] sc1
  global_load_dwordx3 v[76:78], v26, s[16:17] sc1
  global_load_dwordx3 v[80:82], v27, s[16:17] sc1
  s_waitcnt lgkmcnt(8)
  v_mfma_f32_16x16x32_bf16 v[104:107], v[100:103], v[136:139], v[104:107]
  v_mfma_f32_16x16x32_bf16 v[108:111], v[100:103], v[140:143], v[108:111]
  v_mfma_f32_16x16x32_bf16 v[112:115], v[100:103], v[144:147], v[112:115]
  v_mfma_f32_16x16x32_bf16 v[116:119], v[100:103], v[148:151], v[116:119]
  ds_read2_b64 v[100:103], v23 offset0:48 offset1:49
  v_min_u32 v66, -2, v50
  v_add_f32 v50, s55, v50
  s_waitcnt vmcnt(3)
  ds_read_b64_tr_b16 v[136:137], v32 offset:61440
  ds_read_b64_tr_b16 v[138:139], v33 offset:61440
  ds_read_b64_tr_b16 v[140:141], v34 offset:61440
  ds_read_b64_tr_b16 v[142:143], v35 offset:61440
  ds_read_b64_tr_b16 v[144:145], v36 offset:61440
  ds_read_b64_tr_b16 v[146:147], v37 offset:61440
  ds_read_b64_tr_b16 v[148:149], v38 offset:61440
  ds_read_b64_tr_b16 v[150:151], v39 offset:61440
  global_load_dwordx3 v[84:86], v25, s[16:17] sc1
  global_load_dwordx3 v[88:90], v26, s[16:17] sc1
  global_load_dwordx3 v[92:94], v27, s[16:17] sc1
  s_waitcnt lgkmcnt(8)
  v_mfma_f32_16x16x32_bf16 v[104:107], v[96:99], v[120:123], v[104:107]
  v_mfma_f32_16x16x32_bf16 v[108:111], v[96:99], v[124:127], v[108:111]
  v_mfma_f32_16x16x32_bf16 v[112:115], v[96:99], v[128:131], v[112:115]
  v_mfma_f32_16x16x32_bf16 v[116:119], v[96:99], v[132:135], v[116:119]
  s_waitcnt lgkmcnt(6)
  v_mfma_f32_16x16x32_bf16 v[104:107], v[100:103], v[136:139], v[104:107]
  s_waitcnt lgkmcnt(4)
  v_mfma_f32_16x16x32_bf16 v[108:111], v[100:103], v[140:143], v[108:111]
  s_waitcnt lgkmcnt(2)
  v_mfma_f32_16x16x32_bf16 v[112:115], v[100:103], v[144:147], v[112:115]
  s_waitcnt lgkmcnt(0)
  v_mfma_f32_16x16x32_bf16 v[116:119], v[100:103], v[148:151], v[116:119]
  s_nop 1
  v_add_f32 v60, v104, v106
  v_add_f32 v61, v105, v107
  s_mov_b64 exec, s[42:43]
  v_add_f32 v60, v108, v110
  v_add_f32 v61, v109, v111
  s_mov_b64 exec, s[44:45]
  v_add_f32 v60, v112, v114
  v_add_f32 v61, v113, v115
  s_mov_b64 exec, s[46:47]
  v_add_f32 v60, v116, v118
  v_add_f32 v61, v117, v119
  s_mov_b64 exec, -1
  v_add_f32 v64, v48, v60
  v_add_f32 v65, v49, v61
  v_min_u32 v64, -2, v64
  v_min_u32 v65, -2, v65
  global_store_dwordx3 v24, v[64:66], s[16:17]
  global_load_dwordx3 v[164:166], v25, s[16:17] sc1
  global_load_dwordx3 v[168:170], v26, s[16:17] sc1
  global_load_dwordx3 v[172:174], v27, s[16:17] sc1
  s_cbranch_scc0 L_far
  s_waitcnt vmcnt(7)
  v_max3_u32 v4, v72, v73, v74
  s_branch L_sk10
L_hop10:
  s_branch L_hop6
L_xhop10:
  s_branch L_bar1
L_sk10:
  v_max3_u32 v5, v76, v77, v78
  v_max3_u32 v6, v80, v81, v82
  v_max3_u32 v4, v4, v5, v6
  v_cmp_eq_u32 vcc, -1, v4
  s_cbranch_vccz L_o0
  global_load_dwordx3 v[72:74], v25, s[16:17] sc1
  global_load_dwordx3 v[76:78], v26, s[16:17] sc1
  global_load_dwordx3 v[80:82], v27, s[16:17] sc1
  s_waitcnt vmcnt(7)
  v_max3_u32 v4, v84, v85, v86
  v_max3_u32 v5, v88, v89, v90
  v_max3_u32 v6, v92, v93, v94
  v_max3_u32 v4, v4, v5, v6
  v_cmp_eq_u32 vcc, -1, v4
  s_cbranch_vccz L_o1
  global_load_dwordx3 v[84:86], v25, s[16:17] sc1
  global_load_dwordx3 v[88:90], v26, s[16:17] sc1
  global_load_dwordx3 v[92:94], v27, s[16:17] sc1
  s_waitcnt vmcnt(9)
  global_load_dwordx3 v[176:178], v25, s[16:17] sc1
  global_load_dwordx3 v[180:182], v26, s[16:17] sc1
  global_load_dwordx3 v[184:186], v27, s[16:17] sc1
  s_waitcnt vmcnt(9)
  v_max3_u32 v4, v164, v165, v166
  v_max3_u32 v5, v168, v169, v170
  v_max3_u32 v6, v172, v173, v174
  v_max3_u32 v4, v4, v5, v6
  v_cmp_eq_u32 vcc, -1, v4
  s_cbranch_vccz L_o2
  s_waitcnt vmcnt(6)
  v_max3_u32 v4, v72, v73, v74
  v_max3_u32 v5, v76, v77, v78
  v_max3_u32 v6, v80, v81, v82
  v_max3_u32 v4, v4, v5, v6
  v_cmp_eq_u32 vcc, -1, v4
  s_cbranch_vccz L_o0
  s_waitcnt vmcnt(3)
  v_max3_u32 v4, v84, v85, v86
  v_max3_u32 v5, v88, v89, v90
  v_max3_u32 v6, v92, v93, v94
  v_max3_u32 v4, v4, v5, v6
  v_cmp_eq_u32 vcc, -1, v4
  s_cbranch_vccz L_o1
L_fin:
  s_waitcnt vmcnt(0)
  v_max3_u32 v4, v176, v177, v178
  v_max3_u32 v5, v180, v181, v182
  v_max3_u32 v6, v184, v185, v186
  v_max3_u32 v4, v4, v5, v6
  v_cmp_eq_u32 vcc, -1, v4
  s_cbranch_vccnz L_end
L_o3:
  v_add_f32 v29, v178, v182
  v_add_f32 v58, v186, v50
  v_add_f32 v56, v176, v180
  v_add_f32 v29, v29, v58
  v_add_f32 v57, v177, v181
  v_rcp_f32 v29, v29
  v_add_f32 v58, v64, v184
  v_add_f32 v59, v65, v185
  v_add_f32 v56, v56, v58
  v_add_f32 v57, v57, v59
  v_mul_f32 v56, v56, v29
  v_mul_f32 v57, v57, v29
  v_cvt_pk_bf16_f32 v56, v56, v57
  global_store_short v28, v56, s[12:13]
  global_store_short_d16_hi v28, v56, s[12:13] offset:32
  s_endpgm
L_o0:
  v_add_f32 v29, v74, v78
  v_add_f32 v58, v82, v50
  v_add_f32 v56, v72, v76
  v_add_f32 v29, v29, v58
  v_add_f32 v57, v73, v77
  v_rcp_f32 v29, v29
  v_add_f32 v58, v64, v80
  v_add_f32 v59, v65, v81
  v_add_f32 v56, v56, v58
  v_add_f32 v57, v57, v59
  v_mul_f32 v56, v56, v29
  v_mul_f32 v57, v57, v29
  v_cvt_pk_bf16_f32 v56, v56, v57
  global_store_short v28, v56, s[12:13]
  global_store_short_d16_hi v28, v56, s[12:13] offset:32
  s_endpgm
L_o1:
  v_add_f32 v29, v86, v90
  v_add_f32 v58, v94, v50
  v_add_f32 v56, v84, v88
  v_add_f32 v29, v29, v58
  v_add_f32 v57, v85, v89
  s_branch L_sk11
L_hop11:
  s_branch L_hop7
L_xhop11:
  s_branch L_bar1
L_sk11:
  v_rcp_f32 v29, v29
  v_add_f32 v58, v64, v92
  v_add_f32 v59, v65, v93
  v_add_f32 v56, v56, v58
  v_add_f32 v57, v57, v59
  v_mul_f32 v56, v56, v29
  v_mul_f32 v57, v57, v29
  v_cvt_pk_bf16_f32 v56, v56, v57
  global_store_short v28, v56, s[12:13]
  global_store_short_d16_hi v28, v56, s[12:13] offset:32
  s_endpgm
L_o2:
  v_add_f32 v29, v166, v170
  v_add_f32 v58, v174, v50
  v_add_f32 v56, v164, v168
  v_add_f32 v29, v29, v58
  v_add_f32 v57, v165, v169
  v_rcp_f32 v29, v29
  v_add_f32 v58, v64, v172
  v_add_f32 v59, v65, v173
  v_add_f32 v56, v56, v58
  v_add_f32 v57, v57, v59
  v_mul_f32 v56, v56, v29
  v_mul_f32 v57, v57, v29
  v_cvt_pk_bf16_f32 v56, v56, v57
  global_store_short v28, v56, s[12:13]
  global_store_short_d16_hi v28, v56, s[12:13] offset:32
  s_endpgm
L_ev:
  s_cmp_lg_u32 s34, 9
  s_cbranch_scc1 L_ev1
  s_mov_b32 s40, 13
  v_mov_b64 v[8:9], v[12:13]
  v_mov_b64 v[10:11], v[14:15]
  s_mov_b32 s20, s24
  s_mov_b32 s21, s25
  s_sub_u32 s32, s32, 0x80000
  s_branch L_ok
L_ev1:
  s_cmp_lg_u32 s34, 13
  s_cbranch_scc1 L_ev2
  s_mov_b32 s40, 15
  v_mov_b64 v[160:161], -1
  v_mov_b64 v[162:163], -1
  global_store_dwordx3 v24, v[160:162], s[16:17]
  s_branch L_ok
L_ev2:
  s_getreg_b32 s39, hwreg(HW_REG_XCC_ID, 0, 4)
  v_add_u32 v20, s19, v21
  s_or_b32 s39, s39, 16
  v_mov_b32 v22, s39
  s_mul_i32 s39, s39, 0x01010101
  s_mov_b64 exec, 1
  global_store_byte v20, v22, s[14:15]
  s_mov_b64 exec, -1
  s_branch L_ok
L_retry:
  ds_read_b32 v19, v18 offset:16
  s_sub_u32 s58, s58, 1
  s_cbranch_scc1 L_end
  s_branch L_ld
L_retry2:
  ds_read_b32 v19, v18 offset:16
  s_sub_u32 s58, s58, 1
  s_cbranch_scc1 L_end
  s_branch L_md
L_rt16:
  ds_read_b32 v19, v18 offset:16
  s_sub_u32 s58, s58, 1
  s_cbranch_scc1 L_end
  s_waitcnt lgkmcnt(0)
  s_branch L_en16
L_rt18:
  ds_read_b32 v19, v18 offset:16
  s_sub_u32 s58, s58, 1
  s_cbranch_scc1 L_end
  s_waitcnt lgkmcnt(0)
  s_branch L_en18
L_rt21:
  ds_read_b32 v19, v18 offset:16
  s_sub_u32 s58, s58, 1
  s_cbranch_scc1 L_end
  s_waitcnt lgkmcnt(0)
  s_branch L_en21
L_rt23:
  ds_read_b32 v19, v18 offset:16
  s_sub_u32 s58, s58, 1
  s_cbranch_scc1 L_end
  s_waitcnt lgkmcnt(0)
  s_branch L_en23
L_rt24:
  ds_read_b32 v19, v18 offset:16
  s_sub_u32 s58, s58, 1
  s_cbranch_scc1 L_end
  s_waitcnt lgkmcnt(0)
  s_branch L_en24
L_rt25:
  ds_read_b32 v19, v18 offset:16
  s_sub_u32 s58, s58, 1
  s_cbranch_scc1 L_end
  s_waitcnt lgkmcnt(0)
  s_branch L_en25
L_rt26:
  ds_read_b32 v19, v18 offset:16
  s_sub_u32 s58, s58, 1
  s_cbranch_scc1 L_end
  s_waitcnt lgkmcnt(0)
  s_branch L_en26
L_rt27:
  ds_read_b32 v19, v18 offset:16
  s_sub_u32 s58, s58, 1
  s_cbranch_scc1 L_end
  s_waitcnt lgkmcnt(0)
  s_branch L_en27
L_cold:
  s_endpgm
  s_endpgm
  s_endpgm
  s_endpgm
  s_endpgm
  s_endpgm
L_hop12:
  s_branch L_hop16
L_xhop12:
  s_branch L_bar1
L_cons:
  v_lshrrev_b32 v194, 6, v0
  v_and_b32 v205, 63, v0
  v_readfirstlane_b32 s3, v194
  v_lshrrev_b32 v196, 4, v205
  s_and_b32 s3, s3, 3
  v_and_b32 v195, 15, v205
  v_xor_b32 v197, v195, v196
  v_lshlrev_b32 v197, 4, v197
  v_mov_b32 v207, 160512
  s_mov_b32 s55, 923154365
  s_lshl_b32 s35, s3, 12
  v_lshl_add_u32 v182, v195, 8, v197
  v_add_u32 v182, 131072, v182
  v_xor_b32 v183, 64, v182
  v_xor_b32 v184, 0x80, v182
  v_xor_b32 v185, 0xc0, v182
  v_lshrrev_b32 v198, 2, v205
  v_and_b32 v199, 7, v198
  v_lshlrev_b32 v199, 5, v199
  v_lshl_add_u32 v199, v198, 8, v199
  v_and_b32 v198, 3, v205
  v_lshl_add_u32 v199, v198, 3, v199
  v_add_u32 v186, s35, v199
  s_mov_b32 s58, 0x100000
  s_load_dwordx2 s[16:17], s[0:1], 48
  s_mul_i32 s18, s2, 0x101
  s_and_b32 s18, s18, 0x3fc0
  s_lshr_b32 s18, s18, 3
  s_add_u32 s18, s18, s3
  s_lshl_b32 s18, s18, 8
  v_xor_b32 v187, 32, v186
  v_xor_b32 v188, 64, v186
  v_xor_b32 v189, 96, v186
  v_xor_b32 v190, 128, v186
  v_xor_b32 v191, 160, v186
  v_xor_b32 v192, 192, v186
  v_xor_b32 v193, 224, v186
  v_mov_b32 v160, 0x3f803f80
  s_mov_b32 s48, 1050163184
  s_mov_b32 s50, 1069066811
  s_mov_b32 s52, 0xffff0000
  s_lshl_b32 s36, s3, 2
  v_add_u32 v216, s36, v207
  v_mov_b32 v213, 1
  v_mov_b32 v212, 0
  s_lshl_b32 s36, s3, 10
  s_add_u32 s36, s36, 156416
  v_lshl_add_u32 v217, v205, 4, s36
  s_lshl_b32 s36, s3, 7
  s_add_u32 s36, s36, 155392
  v_and_b32 v198, 3, v205
  v_xor_b32 v198, 1, v198
  v_lshl_add_u32 v198, v196, 2, v198
  v_lshl_add_u32 v181, v198, 3, s36
  v_and_b32 v198, 1, v196
  v_cvt_f32_u32 v204, v198
  v_sub_f32 v204, 0, v204
  v_lshrrev_b32 v199, 2, v195
  v_lshl_add_u32 v198, v199, 1, v198
  v_lshl_add_u32 v198, v198, 4, s36
  v_and_b32 v199, 3, v205
  v_lshl_add_u32 v180, v199, 1, v198
  s_sub_u32 s36, s36, 7680
  v_lshrrev_b32 v198, 3, v205
  v_and_b32 v199, 7, v205
  v_lshl_add_u32 v198, v198, 5, v199
  v_lshl_add_u32 v199, v198, 4, s36
  s_mov_b32 s49, s48
  s_mov_b32 s51, s50
  v_mov_b64 v[140:141], 0
  v_mov_b64 v[142:143], 0
  v_mov_b64 v[144:145], 0
  v_mov_b64 v[146:147], 0
  v_mov_b64 v[148:149], 0
  v_mov_b64 v[150:151], 0
  v_mov_b64 v[152:153], 0
  v_mov_b64 v[154:155], 0
  v_mov_b64 v[156:157], 0
  v_mov_b64 v[112:113], 0
  v_mov_b64 v[114:115], 0
  ds_write_b128 v199, v[112:115] offset:0
  ds_write_b128 v199, v[112:115] offset:4096
  ds_write_b128 v199, v[112:115] offset:4608
  s_waitcnt lgkmcnt(0)
  s_load_dword s19, s[16:17], s18 offset:0
  s_load_dword s19, s[16:17], s18 offset:64
  s_load_dword s19, s[16:17], s18 offset:128
  s_branch L_sk13
L_hop13:
  s_branch L_hop17
L_xhop13:
  s_branch L_bar1
L_sk13:
  s_load_dword s19, s[16:17], s18 offset:192
  v_lshrrev_b32 v202, 4, v205
  v_lshlrev_b32 v202, 4, v202
  v_add_u32 v202, 147456, v202
  v_cmp_gt_i32 vcc, 6, v212
  s_cbranch_vccz L_pd28
L_p28:
  ds_read_b32 v212, v207
  s_sub_u32 s58, s58, 1
  s_cbranch_scc1 L_end
  s_waitcnt lgkmcnt(0)
  v_cmp_gt_i32 vcc, 6, v212
  s_cbranch_vccnz L_p28
L_pd28:
  ds_read_b128 v[64:67], v202 offset:0
  ds_read_b128 v[68:71], v202 offset:64
  ds_read_b128 v[72:75], v202 offset:128
  ds_read_b128 v[76:79], v202 offset:192
  ds_read_b128 v[0:3], v182 offset:0
  ds_read_b128 v[16:19], v182 offset:4096
  ds_read_b128 v[32:35], v182 offset:8192
  ds_read_b128 v[48:51], v182 offset:12288
  ds_read_b128 v[4:7], v183 offset:0
  ds_read_b128 v[20:23], v183 offset:4096
  ds_read_b128 v[36:39], v183 offset:8192
  ds_read_b128 v[52:55], v183 offset:12288
  s_waitcnt lgkmcnt(8)
  v_lshlrev_b32 v130, 16, v67
  v_lshlrev_b32 v168, 16, v74
  v_lshlrev_b32 v138, 16, v71
  ds_read_b128 v[8:11], v184 offset:0
  ds_read_b128 v[24:27], v184 offset:4096
  ds_read_b128 v[40:43], v184 offset:8192
  v_lshlrev_b32 v164, 16, v72
  v_lshlrev_b32 v132, 16, v68
  v_and_b32 v171, s52, v75
  v_mul_f32 v164, s48, v164
  v_lshlrev_b32 v124, 16, v64
  v_mul_f32 v171, s48, v171
  v_and_b32 v127, s52, v65
  v_and_b32 v175, s52, v77
  v_mul_f32 v175, s48, v175
  v_and_b32 v165, s52, v72
  ds_read_b128 v[56:59], v184 offset:12288
  v_mul_f32 v165, s48, v165
  v_lshlrev_b32 v136, 16, v70
  v_and_b32 v169, s52, v74
  v_mul_f32 v130, s48, v130
  v_lshlrev_b32 v126, 16, v65
  v_mul_f32 v168, s48, v168
  v_mul_f32 v136, s48, v136
  v_and_b32 v129, s52, v66
  v_mul_f32 v129, s48, v129
  v_and_b32 v135, s52, v69
  v_mul_f32 v135, s48, v135
  v_mul_f32 v169, s48, v169
  v_cvt_pk_bf16_f32 v234, v168, v169
  v_lshlrev_b32 v128, 16, v66
  v_lshlrev_b32 v176, 16, v78
  v_lshlrev_b32 v174, 16, v77
  v_mul_f32 v174, s48, v174
  v_and_b32 v177, s52, v78
  v_and_b32 v125, s52, v64
  v_mul_f32 v124, s48, v124
  v_lshlrev_b32 v170, 16, v75
  v_mul_f32 v170, s48, v170
  v_mul_f32 v176, s48, v176
  v_lshlrev_b32 v178, 16, v79
  v_mul_f32 v178, s48, v178
  v_and_b32 v137, s52, v70
  v_mul_f32 v137, s48, v137
  v_lshlrev_b32 v134, 16, v69
  v_mul_f32 v134, s48, v134
  v_cvt_pk_bf16_f32 v229, v134, v135
  v_mul_f32 v126, s48, v126
  ds_read_b128 v[12:15], v185 offset:0
  v_and_b32 v131, s52, v67
  v_mul_f32 v131, s48, v131
  v_cvt_pk_bf16_f32 v227, v130, v131
  v_and_b32 v167, s52, v73
  v_mul_f32 v167, s48, v167
  v_lshlrev_b32 v166, 16, v73
  v_mul_f32 v127, s48, v127
  v_cvt_pk_bf16_f32 v225, v126, v127
  v_lshlrev_b32 v172, 16, v76
  v_mul_f32 v172, s48, v172
  v_mul_f32 v177, s48, v177
  v_cvt_pk_bf16_f32 v238, v176, v177
  v_cvt_pk_bf16_f32 v235, v170, v171
  ds_read_b128 v[28:31], v185 offset:4096
  ds_read_b128 v[44:47], v185 offset:8192
  ds_read_b128 v[60:63], v185 offset:12288
  v_mul_f32 v166, s48, v166
  v_cvt_pk_bf16_f32 v233, v166, v167
  v_mul_f32 v138, s48, v138
  v_mul_f32 v128, s48, v128
  v_and_b32 v179, s52, v79
  s_branch L_sk14
L_hop14:
  s_branch L_hop18
L_xhop14:
  s_branch L_bar1
L_sk14:
  v_mul_f32 v179, s48, v179
  v_cvt_pk_bf16_f32 v239, v178, v179
  v_and_b32 v139, s52, v71
  v_mul_f32 v139, s48, v139
  v_cvt_pk_bf16_f32 v231, v138, v139
  v_and_b32 v133, s52, v68
  v_mul_f32 v133, s48, v133
  v_and_b32 v173, s52, v76
  v_mul_f32 v173, s48, v173
  v_cvt_pk_bf16_f32 v236, v172, v173
  v_cvt_pk_bf16_f32 v237, v174, v175
  v_cvt_pk_bf16_f32 v230, v136, v137
  v_cvt_pk_bf16_f32 v232, v164, v165
  v_cvt_pk_bf16_f32 v226, v128, v129
  v_mul_f32 v125, s48, v125
  v_cvt_pk_bf16_f32 v224, v124, v125
  v_dot2_f32_bf16 v202, v224, v224, 0
  v_mul_f32 v132, s48, v132
  v_cvt_pk_bf16_f32 v228, v132, v133
  s_sub_u32 s36, s35, 131072
  v_dot2c_f32_bf16 v202, v225, v225
  v_add_u32 v183, s36, v183
  v_add_u32 v184, s36, v184
  v_add_u32 v182, s36, v182
  v_add_u32 v185, s36, v185
  v_dot2c_f32_bf16 v202, v226, v226
  v_dot2c_f32_bf16 v202, v227, v227
  v_dot2c_f32_bf16 v202, v228, v228
  v_dot2c_f32_bf16 v202, v229, v229
  v_dot2c_f32_bf16 v202, v230, v230
  v_dot2c_f32_bf16 v202, v231, v231
  v_dot2c_f32_bf16 v202, v232, v232
  v_dot2c_f32_bf16 v202, v233, v233
  v_dot2c_f32_bf16 v202, v234, v234
  v_dot2c_f32_bf16 v202, v235, v235
  v_dot2c_f32_bf16 v202, v236, v236
  v_dot2c_f32_bf16 v202, v237, v237
  v_dot2c_f32_bf16 v202, v238, v238
  v_dot2c_f32_bf16 v202, v239, v239
  s_add_u32 s33, s3, 5
  s_waitcnt lgkmcnt(12)
  v_mfma_f32_16x16x32_bf16 v[84:87], v[16:19], v[224:227], 0
  s_waitcnt lgkmcnt(8)
  v_mov_b32 v203, v202
  v_mfma_f32_16x16x32_bf16 v[84:87], v[20:23], v[228:231], v[84:87]
  s_waitcnt lgkmcnt(4)
  v_permlane32_swap_b32 v202, v203
  v_mfma_f32_16x16x32_bf16 v[84:87], v[24:27], v[232:235], v[84:87]
  s_waitcnt lgkmcnt(0)
  v_add_f32 v202, v202, v203
  v_mov_b32 v203, v202
  v_mfma_f32_16x16x32_bf16 v[84:87], v[28:31], v[236:239], v[84:87]
  v_mfma_f32_16x16x32_bf16 v[92:95], v[48:51], v[224:227], 0
  v_permlane16_swap_b32 v202, v203
  v_mfma_f32_16x16x32_bf16 v[92:95], v[52:55], v[228:231], v[92:95]
  v_add_f32 v202, v202, v203
  v_cvt_pk_bf16_f32 v202, 0, v202
  v_mfma_f32_16x16x32_bf16 v[88:91], v[32:35], v[224:227], 0
  v_mul_f32 v202, -0.5, v202
  v_mfma_f32_16x16x32_bf16 v[88:91], v[36:39], v[228:231], v[88:91]
  v_cvt_pk_bf16_f32 v85, 0, v85
  v_cvt_pk_bf16_f32 v84, 0, v84
  v_add_f32 v84, v84, v202
  v_cvt_pk_bf16_f32 v84, 0, v84
  v_mul_f32 v84, s50, v84
  v_exp_f32 v84, v84
  v_mfma_f32_16x16x32_bf16 v[88:91], v[40:43], v[232:235], v[88:91]
  v_cvt_pk_bf16_f32 v87, 0, v87
  v_add_f32 v87, v87, v202
  v_mfma_f32_16x16x32_bf16 v[88:91], v[44:47], v[236:239], v[88:91]
  v_cvt_pk_bf16_f32 v87, 0, v87
  v_add_f32 v85, v85, v202
  v_cvt_pk_bf16_f32 v85, 0, v85
  v_mul_f32 v85, s50, v85
  v_mfma_f32_16x16x32_bf16 v[80:83], v[0:3], v[224:227], 0
  v_exp_f32 v85, v85
  v_mfma_f32_16x16x32_bf16 v[80:83], v[4:7], v[228:231], v[80:83]
  v_mul_f32 v87, s50, v87
  v_cvt_pk_bf16_f32 v91, 0, v91
  v_mfma_f32_16x16x32_bf16 v[80:83], v[8:11], v[232:235], v[80:83]
  v_cvt_pk_bf16_f32 v88, 0, v88
  v_add_f32 v91, v91, v202
  v_mfma_f32_16x16x32_bf16 v[80:83], v[12:15], v[236:239], v[80:83]
  v_cvt_pk_bf16_f32 v91, 0, v91
  v_exp_f32 v87, v87
  v_cvt_pk_bf16_f32 v90, 0, v90
  v_add_f32 v90, v90, v202
  v_cvt_pk_bf16_f32 v90, 0, v90
  s_branch L_sk15
L_hop15:
  s_branch L_hop19
L_xhop15:
  s_branch L_bar1
L_sk15:
  v_mul_f32 v90, s50, v90
  v_exp_f32 v90, v90
  v_mfma_f32_16x16x32_bf16 v[92:95], v[56:59], v[232:235], v[92:95]
  v_cvt_pk_bf16_f32 v82, 0, v82
  v_cvt_pk_bf16_f32 v81, 0, v81
  v_add_f32 v81, v81, v202
  v_cvt_pk_bf16_f32 v81, 0, v81
  v_cvt_pk_bf16_f32 v83, 0, v83
  v_add_f32 v83, v83, v202
  v_cvt_pk_bf16_f32 v83, 0, v83
  v_mul_f32 v81, s50, v81
  v_exp_f32 v81, v81
  v_add_f32 v82, v82, v202
  v_cvt_pk_bf16_f32 v82, 0, v82
  v_mul_f32 v82, s50, v82
  v_exp_f32 v82, v82
  v_mul_f32 v83, s50, v83
  v_add_f32 v88, v88, v202
  v_exp_f32 v83, v83
  v_mfma_f32_16x16x32_bf16 v[92:95], v[60:63], v[236:239], v[92:95]
  v_cvt_pk_bf16_f32 v89, 0, v89
  v_add_f32 v89, v89, v202
  v_cvt_pk_bf16_f32 v89, 0, v89
  v_mul_f32 v89, s50, v89
  v_exp_f32 v89, v89
  v_cvt_pk_bf16_f32 v86, 0, v86
  v_add_f32 v86, v86, v202
  v_cvt_pk_bf16_f32 v86, 0, v86
  v_cvt_pk_bf16_f32 v95, 0, v95
  v_cvt_pk_bf16_f32 v94, 0, v94
  v_cvt_pk_bf16_f32 v92, 0, v92
  v_mul_f32 v86, s50, v86
  v_cvt_pk_bf16_f32 v93, 0, v93
  v_add_f32 v93, v93, v202
  v_cvt_pk_bf16_f32 v93, 0, v93
  v_add_f32 v95, v95, v202
  v_cvt_pk_bf16_f32 v95, 0, v95
  v_add_f32 v94, v94, v202
  v_cvt_pk_bf16_f32 v94, 0, v94
  v_mul_f32 v94, s50, v94
  v_exp_f32 v94, v94
  v_mul_f32 v93, s50, v93
  v_exp_f32 v93, v93
  v_exp_f32 v86, v86
  v_mul_f32 v95, s50, v95
  v_exp_f32 v95, v95
  v_mul_f32 v91, s50, v91
  v_exp_f32 v91, v91
  v_add_f32 v92, v92, v202
  v_cvt_pk_bf16_f32 v92, 0, v92
  v_mul_f32 v92, s50, v92
  v_exp_f32 v92, v92
  v_cvt_pk_bf16_f32 v88, 0, v88
  v_mul_f32 v88, s50, v88
  v_exp_f32 v88, v88
  v_cvt_pk_bf16_f32 v80, 0, v80
  v_add_f32 v80, v80, v202
  v_cvt_pk_bf16_f32 v80, 0, v80
  v_mul_f32 v80, s50, v80
  v_exp_f32 v80, v80
  s_mov_b32 s53, 897988541
  v_mov_b32 v194, s53
  s_mov_b32 s54, 1040187392
  v_cmp_gt_i32 vcc, s33, v212
  s_cbranch_vccz L_pd29
L_p29:
  ds_read_b32 v212, v207
  s_sub_u32 s58, s58, 1
  s_cbranch_scc1 L_end
  s_waitcnt lgkmcnt(0)
  v_cmp_gt_i32 vcc, s33, v212
  s_cbranch_vccnz L_p29
L_pd29:
  ds_read_b128 v[64:67], v182
  ds_read_b128 v[68:71], v183
  ds_read_b128 v[72:75], v184
  ds_read_b128 v[76:79], v185
  v_cvt_pk_bf16_f32 v80, 0, v80
  v_cvt_pk_bf16_f32 v81, 0, v81
  v_cvt_pk_bf16_f32 v82, 0, v82
  v_cvt_pk_bf16_f32 v83, 0, v83
  v_cvt_pk_bf16_f32 v84, 0, v84
  v_cvt_pk_bf16_f32 v85, 0, v85
  v_cvt_pk_bf16_f32 v86, 0, v86
  v_cvt_pk_bf16_f32 v87, 0, v87
  v_cvt_pk_bf16_f32 v88, 0, v88
  v_cvt_pk_bf16_f32 v89, 0, v89
  s_branch L_sk16
L_hop16:
  s_branch L_cons
L_xhop16:
  s_branch L_bar1
L_sk16:
  v_cvt_pk_bf16_f32 v90, 0, v90
  v_cvt_pk_bf16_f32 v91, 0, v91
  v_cvt_pk_bf16_f32 v92, 0, v92
  v_cvt_pk_bf16_f32 v93, 0, v93
  v_cvt_pk_bf16_f32 v94, 0, v94
  v_cvt_pk_bf16_f32 v95, 0, v95
  v_fma_f32 v80, v80, s54, v194
  v_fma_f32 v81, v81, s54, v194
  v_fma_f32 v82, v82, s54, v194
  v_fma_f32 v83, v83, s54, v194
  v_fma_f32 v84, v84, s54, v194
  v_fma_f32 v85, v85, s54, v194
  v_fma_f32 v86, v86, s54, v194
  v_fma_f32 v87, v87, s54, v194
  v_fma_f32 v88, v88, s54, v194
  v_fma_f32 v89, v89, s54, v194
  v_fma_f32 v90, v90, s54, v194
  v_fma_f32 v91, v91, s54, v194
  v_fma_f32 v92, v92, s54, v194
  v_fma_f32 v93, v93, s54, v194
  v_fma_f32 v94, v94, s54, v194
  v_fma_f32 v95, v95, s54, v194
  v_cvt_pk_bf16_f32 v100, v80, v81
  v_cvt_pk_bf16_f32 v101, v82, v83
  v_cvt_pk_bf16_f32 v102, v84, v85
  v_cvt_pk_bf16_f32 v103, v86, v87
  v_cvt_pk_bf16_f32 v104, v88, v89
  v_cvt_pk_bf16_f32 v105, v90, v91
  v_cvt_pk_bf16_f32 v106, v92, v93
  v_cvt_pk_bf16_f32 v107, v94, v95
  s_mov_b32 s34, 0
  v_mov_b32 v108, 0
  v_dot2c_f32_bf16 v108, v100, v160
  v_dot2c_f32_bf16 v108, v101, v160
  v_dot2c_f32_bf16 v108, v102, v160
  v_dot2c_f32_bf16 v108, v103, v160
  v_dot2c_f32_bf16 v108, v104, v160
  v_dot2c_f32_bf16 v108, v105, v160
  v_dot2c_f32_bf16 v108, v106, v160
  v_dot2c_f32_bf16 v108, v107, v160
  s_mov_b32 s31, 0x1c000
  s_mov_b32 s28, 49152
  s_mov_b32 s27, 262144
  s_movk_i32 s26, 0x200
  s_mov_b32 s25, 1
  s_waitcnt lgkmcnt(0)
  ds_write_b32 v216, v213 offset:16
  v_mul_f32 v108, s55, v108
L_loop:
  v_and_b32 v131, s52, v67
  v_and_b32 v169, s52, v74
  v_and_b32 v173, s52, v76
  v_and_b32 v125, s52, v64
  v_mul_f32 v125, s48, v125
  v_lshlrev_b32 v136, 16, v70
  v_and_b32 v135, s52, v69
  v_mul_f32 v131, s48, v131
  v_lshlrev_b32 v134, 16, v69
  v_mul_f32 v134, s48, v134
  v_lshlrev_b32 v132, 16, v68
  v_mul_f32 v132, s48, v132
  v_lshlrev_b32 v130, 16, v67
  v_and_b32 v177, s52, v78
  v_mul_f32 v177, s48, v177
  v_lshlrev_b32 v138, 16, v71
  v_lshlrev_b32 v128, 16, v66
  v_mul_f32 v128, s48, v128
  v_mul_f32 v135, s48, v135
  v_and_b32 v139, s52, v71
  v_mul_f32 v130, s48, v130
  v_cvt_pk_bf16_f32 v227, v130, v131
  v_cvt_pk_bf16_f32 v229, v134, v135
  v_lshlrev_b32 v126, 16, v65
  v_mul_f32 v173, s48, v173
  v_lshlrev_b32 v168, 16, v74
  v_and_b32 v175, s52, v77
  v_mul_f32 v175, s48, v175
  v_mul_f32 v126, s48, v126
  v_lshlrev_b32 v170, 16, v75
  v_mul_f32 v136, s48, v136
  v_and_b32 v133, s52, v68
  v_and_b32 v137, s52, v70
  v_mul_f32 v137, s48, v137
  v_mul_f32 v138, s48, v138
  v_cvt_pk_bf16_f32 v230, v136, v137
  v_lshlrev_b32 v124, 16, v64
  v_mul_f32 v124, s48, v124
  v_cvt_pk_bf16_f32 v224, v124, v125
  s_branch L_sk17
L_hop17:
  s_branch L_cons
L_xhop17:
  s_branch L_bar1
L_sk17:
  v_dot2_f32_bf16 v202, v224, v224, 0
  v_and_b32 v127, s52, v65
  v_mul_f32 v127, s48, v127
  v_cvt_pk_bf16_f32 v225, v126, v127
  v_dot2c_f32_bf16 v202, v225, v225
  v_mul_f32 v133, s48, v133
  v_cvt_pk_bf16_f32 v228, v132, v133
  v_lshlrev_b32 v172, 16, v76
  v_and_b32 v129, s52, v66
  v_mul_f32 v129, s48, v129
  v_cvt_pk_bf16_f32 v226, v128, v129
  v_mul_f32 v139, s48, v139
  v_cvt_pk_bf16_f32 v231, v138, v139
  v_mfma_f32_16x16x32_bf16 v[80:83], v[0:3], v[224:227], 0
  s_mov_b32 s30, s34
  v_and_b32 v171, s52, v75
  v_mul_f32 v171, s48, v171
  v_mfma_f32_16x16x32_bf16 v[80:83], v[4:7], v[228:231], v[80:83]
  s_addk_i32 s34, 0x4000
  v_mul_f32 v169, s48, v169
  v_lshlrev_b32 v166, 16, v73
  v_mul_f32 v166, s48, v166
  v_mfma_f32_16x16x32_bf16 v[84:87], v[16:19], v[224:227], 0
  s_xor_b32 s29, s30, s34
  v_and_b32 v165, s52, v72
  v_lshlrev_b32 v178, 16, v79
  v_mul_f32 v178, s48, v178
  v_mfma_f32_16x16x32_bf16 v[84:87], v[20:23], v[228:231], v[84:87]
  s_and_b32 s29, s29, s31
  v_xor_b32 v185, s29, v185
  v_xor_b32 v184, s29, v184
  v_mfma_f32_16x16x32_bf16 v[88:91], v[32:35], v[224:227], 0
  s_add_u32 s33, s33, 4
  v_xor_b32 v183, s29, v183
  v_cmp_gt_i32 vcc, s33, v212
  v_mfma_f32_16x16x32_bf16 v[88:91], v[36:39], v[228:231], v[88:91]
  s_cmp_ge_u32 s34, s28
  v_xor_b32 v182, s29, v182
  v_mul_f32 v172, s48, v172
  v_cvt_pk_bf16_f32 v236, v172, v173
  v_mfma_f32_16x16x32_bf16 v[92:95], v[48:51], v[224:227], 0
  v_and_b32 v179, s52, v79
  v_mul_f32 v179, s48, v179
  v_mfma_f32_16x16x32_bf16 v[92:95], v[52:55], v[228:231], v[92:95]
  v_mul_f32 v170, s48, v170
  v_cvt_pk_bf16_f32 v235, v170, v171
  v_mul_f32 v165, s48, v165
  v_and_b32 v167, s52, v73
  v_mul_f32 v167, s48, v167
  v_cvt_pk_bf16_f32 v233, v166, v167
  v_cvt_pk_bf16_f32 v239, v178, v179
  v_mul_f32 v168, s48, v168
  v_cvt_pk_bf16_f32 v234, v168, v169
  v_lshlrev_b32 v164, 16, v72
  v_mul_f32 v164, s48, v164
  v_cvt_pk_bf16_f32 v232, v164, v165
  v_dot2c_f32_bf16 v202, v226, v226
  v_dot2c_f32_bf16 v202, v227, v227
  v_mfma_f32_16x16x32_bf16 v[80:83], v[8:11], v[232:235], v[80:83]
  v_lshlrev_b32 v176, 16, v78
  v_mul_f32 v176, s48, v176
  v_cvt_pk_bf16_f32 v238, v176, v177
  v_lshlrev_b32 v174, 16, v77
  v_mul_f32 v174, s48, v174
  v_dot2c_f32_bf16 v202, v228, v228
  v_cvt_pk_bf16_f32 v237, v174, v175
  v_dot2c_f32_bf16 v202, v229, v229
  v_dot2c_f32_bf16 v202, v230, v230
  v_mfma_f32_16x16x32_bf16 v[80:83], v[12:15], v[236:239], v[80:83]
  s_cbranch_scc1 L_thop
L_tback:
  v_mfma_f32_16x16x32_bf16 v[84:87], v[24:27], v[232:235], v[84:87]
  s_cbranch_vccnz L_kr
L_kb:
  ds_read_b128 v[64:67], v182
  ds_read_b128 v[68:71], v183
  v_mfma_f32_16x16x32_bf16 v[84:87], v[28:31], v[236:239], v[84:87]
  ds_read_b128 v[72:75], v184
  ds_read_b128 v[76:79], v185
  ds_read_b32 v212, v207
  v_cvt_pk_bf16_f32 v83, 0, v83
  v_cvt_pk_bf16_f32 v81, 0, v81
  v_dot2c_f32_bf16 v202, v231, v231
  v_dot2c_f32_bf16 v202, v232, v232
  v_dot2c_f32_bf16 v202, v233, v233
  v_dot2c_f32_bf16 v202, v234, v234
  v_dot2c_f32_bf16 v202, v235, v235
  v_dot2c_f32_bf16 v202, v236, v236
  v_dot2c_f32_bf16 v202, v237, v237
  v_dot2c_f32_bf16 v202, v238, v238
  v_dot2c_f32_bf16 v202, v239, v239
  v_cvt_pk_bf16_f32 v86, 0, v86
  v_cvt_pk_bf16_f32 v82, 0, v82
  s_branch L_sk18
L_hop18:
  s_branch L_cons
L_xhop18:
  s_branch L_bar1
L_sk18:
  v_cvt_pk_bf16_f32 v80, 0, v80
  v_permlane32_swap_b32 v202, v112
  v_add_f32 v202, v202, v112
  v_mov_b32 v203, v202
  v_add_u32 v213, s25, v213
  v_cvt_pk_bf16_f32 v87, 0, v87
  v_permlane16_swap_b32 v202, v203
  v_add_f32 v202, v202, v203
  v_mov_b32 v112, v202
  v_cvt_pk_bf16_f32 v84, 0, v84
  v_cvt_pk_bf16_f32 v85, 0, v85
  v_permlane32_swap_b32 v202, v112
  v_cvt_pk_bf16_f32 v116, 0, v112
  v_cvt_pk_bf16_f32 v202, 0, v202
  v_add_f32 v156, v156, v112
  v_fma_f32 v116, v116, v204, v112
  v_cvt_pk_bf16_f32 v116, v116, v116
  v_mul_f32 v202, -0.5, v202
  v_add_f32 v83, v83, v202
  v_cvt_pk_bf16_f32 v83, 0, v83
  v_add_f32 v80, v80, v202
  v_add_f32 v85, v85, v202
  v_cvt_pk_bf16_f32 v85, 0, v85
  v_cvt_pk_bf16_f32 v80, 0, v80
  v_mul_f32 v83, s50, v83
  v_exp_f32 v83, v83
  v_add_f32 v81, v81, v202
  v_cvt_pk_bf16_f32 v81, 0, v81
  v_mul_f32 v81, s50, v81
  v_add_f32 v82, v82, v202
  v_cvt_pk_bf16_f32 v82, 0, v82
  v_mul_f32 v85, s50, v85
  v_mul_f32 v82, s50, v82
  v_exp_f32 v82, v82
  v_exp_f32 v81, v81
  v_cvt_pk_bf16_f32 v225, v82, v83
  v_mul_f32 v80, s50, v80
  v_exp_f32 v80, v80
  v_exp_f32 v85, v85
  v_cvt_pk_bf16_f32 v224, v80, v81
  v_dot2_f32_bf16 v112, v224, v100, v108
  v_add_f32 v84, v84, v202
  v_cvt_pk_bf16_f32 v84, 0, v84
  v_mul_f32 v84, s50, v84
  v_dot2c_f32_bf16 v112, v225, v101
  v_exp_f32 v84, v84
  v_add_f32 v86, v86, v202
  v_cvt_pk_bf16_f32 v226, v84, v85
  v_cvt_pk_bf16_f32 v86, 0, v86
  v_mul_f32 v86, s50, v86
  v_exp_f32 v86, v86
  v_dot2c_f32_bf16 v112, v226, v102
  v_mfma_f32_16x16x32_bf16 v[88:91], v[40:43], v[232:235], v[88:91]
  s_waitcnt lgkmcnt(0)
  ds_write_b32 v216, v213 offset:16
  ds_write_b16 v180, v116 offset:520
  v_mfma_f32_16x16x32_bf16 v[88:91], v[44:47], v[236:239], v[88:91]
  s_cmp_lt_u32 s34, s27
  v_subrev_u32 v180, s26, v180
  v_add_f32 v87, v87, v202
  v_mfma_f32_16x16x32_bf16 v[92:95], v[56:59], v[232:235], v[92:95]
  v_cvt_pk_bf16_f32 v87, 0, v87
  v_mul_f32 v87, s50, v87
  v_mfma_f32_16x16x32_bf16 v[92:95], v[60:63], v[236:239], v[92:95]
  v_exp_f32 v87, v87
  v_cvt_pk_bf16_f32 v90, 0, v90
  v_cvt_pk_bf16_f32 v89, 0, v89
  v_add_f32 v89, v89, v202
  v_cvt_pk_bf16_f32 v227, v86, v87
  v_cvt_pk_bf16_f32 v91, 0, v91
  v_cvt_pk_bf16_f32 v89, 0, v89
  v_mul_f32 v89, s50, v89
  v_cvt_pk_bf16_f32 v93, 0, v93
  v_cvt_pk_bf16_f32 v92, 0, v92
  v_cvt_pk_bf16_f32 v94, 0, v94
  v_cvt_pk_bf16_f32 v95, 0, v95
  v_add_f32 v91, v91, v202
  v_exp_f32 v89, v89
  v_dot2c_f32_bf16 v112, v227, v103
  v_cvt_pk_bf16_f32 v88, 0, v88
  v_add_f32 v95, v95, v202
  v_cvt_pk_bf16_f32 v95, 0, v95
  v_mul_f32 v95, s50, v95
  v_exp_f32 v95, v95
  v_add_f32 v92, v92, v202
  v_cvt_pk_bf16_f32 v91, 0, v91
  v_add_f32 v88, v88, v202
  s_branch L_sk19
L_hop19:
  s_branch L_cons
L_xhop19:
  s_branch L_bar1
L_sk19:
  v_mul_f32 v91, s50, v91
  v_exp_f32 v91, v91
  v_cvt_pk_bf16_f32 v92, 0, v92
  v_mul_f32 v92, s50, v92
  v_exp_f32 v92, v92
  v_cvt_pk_bf16_f32 v88, 0, v88
  v_mul_f32 v88, s50, v88
  v_exp_f32 v88, v88
  v_add_f32 v93, v93, v202
  v_cvt_pk_bf16_f32 v93, 0, v93
  v_cvt_pk_bf16_f32 v228, v88, v89
  v_mul_f32 v93, s50, v93
  v_dot2c_f32_bf16 v112, v228, v104
  v_exp_f32 v93, v93
  v_add_f32 v90, v90, v202
  v_cvt_pk_bf16_f32 v90, 0, v90
  v_cvt_pk_bf16_f32 v230, v92, v93
  v_mul_f32 v90, s50, v90
  v_exp_f32 v90, v90
  v_add_f32 v94, v94, v202
  v_cvt_pk_bf16_f32 v229, v90, v91
  v_dot2c_f32_bf16 v112, v229, v105
  v_cvt_pk_bf16_f32 v94, 0, v94
  v_mul_f32 v94, s50, v94
  v_exp_f32 v94, v94
  v_dot2c_f32_bf16 v112, v230, v106
  v_cvt_pk_bf16_f32 v231, v94, v95
  v_dot2c_f32_bf16 v112, v231, v107
  s_cbranch_scc1 L_loop
  s_branch L_tail
L_kr:
  ds_read_b32 v212, v207
  s_sub_u32 s58, s58, 1
  s_cbranch_scc1 L_end
  s_waitcnt lgkmcnt(0)
  v_cmp_gt_i32 vcc, s33, v212
  s_cbranch_vccnz L_kr
  s_branch L_kb
L_klast:
  s_mov_b32 s25, 0
  s_mov_b64 vcc, 0
  s_branch L_tback
L_thop:
  s_cmp_eq_u32 s34, s27
  s_cbranch_scc1 L_klast
  s_mov_b32 s28, s27
  s_cmp_eq_u32 s3, 0
  s_cbranch_scc1 L_hop20
  s_cmp_eq_u32 s3, 1
  s_cbranch_scc1 L_hop11
  s_cmp_eq_u32 s3, 2
  s_cbranch_scc1 L_hop10
  s_branch L_hop9
L_tail:
  s_mov_b32 s27, 458752
  s_nop 0
  v_mov_b32 v203, v112
  s_nop 1
  v_permlane32_swap_b32 v112, v203
  v_add_f32 v112, v112, v203
  v_mov_b32 v203, v112
  s_nop 1
  v_permlane16_swap_b32 v112, v203
  v_add_f32 v112, v112, v203
  v_cvt_pk_bf16_f32 v116, 0, v112
  v_fma_f32 v116, v116, v204, v112
  v_cvt_pk_bf16_f32 v116, v116, v116
  v_add_f32 v156, v156, v112
  ds_write_b16 v180, v116 offset:520
  s_nop 0
  v_add_f32_dpp v156, v156, v156 row_ror:8 row_mask:0xf bank_mask:0xf
  s_nop 1
  v_add_f32_dpp v156, v156, v156 row_ror:4 row_mask:0xf bank_mask:0xf
  s_nop 1
  v_add_f32_dpp v156, v156, v156 row_ror:2 row_mask:0xf bank_mask:0xf
  s_nop 1
  v_add_f32_dpp v210, v156, v156 row_ror:1 row_mask:0xf bank_mask:0xf
L_v:
  v_cmp_gt_i32 vcc, s33, v212
  s_cbranch_vccz L_pd30
L_p30:
  ds_read_b32 v212, v207
  s_sub_u32 s58, s58, 1
  s_cbranch_scc1 L_end
  s_waitcnt lgkmcnt(0)
  v_cmp_gt_i32 vcc, s33, v212
  s_cbranch_vccnz L_p30
L_pd30:
  ds_read2_b64 v[116:119], v181 offset1:1
  ds_read_b64_tr_b16 v[124:125], v186
  ds_read_b64_tr_b16 v[126:127], v187
  ds_read_b64_tr_b16 v[128:129], v188
  ds_read_b64_tr_b16 v[130:131], v189
  ds_read_b64_tr_b16 v[132:133], v190
  ds_read_b64_tr_b16 v[134:135], v191
  ds_read_b64_tr_b16 v[136:137], v192
  ds_read_b64_tr_b16 v[138:139], v193
  s_mov_b32 s30, s34
  s_addk_i32 s34, 0x4000
  s_xor_b32 s29, s30, s34
  s_and_b32 s29, s29, s31
  s_add_u32 s33, s33, 4
  v_add_u32 v213, 1, v213
  s_branch L_sk20
L_hop20:
  s_branch L_hop8
L_xhop20:
  s_branch L_bar1
L_sk20:
  v_subrev_u32 v181, s26, v181
  v_xor_b32 v186, s29, v186
  v_xor_b32 v187, s29, v187
  v_xor_b32 v188, s29, v188
  v_xor_b32 v189, s29, v189
  v_xor_b32 v190, s29, v190
  v_xor_b32 v191, s29, v191
  v_xor_b32 v192, s29, v192
  v_xor_b32 v193, s29, v193
  s_cmp_lt_u32 s34, s27
  s_waitcnt lgkmcnt(6)
  v_mfma_f32_16x16x32_bf16 v[140:143], v[116:119], v[124:127], v[140:143]
  s_waitcnt lgkmcnt(4)
  v_mfma_f32_16x16x32_bf16 v[144:147], v[116:119], v[128:131], v[144:147]
  s_waitcnt lgkmcnt(2)
  v_mfma_f32_16x16x32_bf16 v[148:151], v[116:119], v[132:135], v[148:151]
  s_waitcnt lgkmcnt(0)
  ds_write_b32 v216, v213 offset:16
  v_mfma_f32_16x16x32_bf16 v[152:155], v[116:119], v[136:139], v[152:155]
  s_cbranch_scc1 L_v
  v_add_u32 v213, 1, v213
  v_add_f32 v208, v140, v142
  v_add_f32 v209, v141, v143
  s_lshl_b64 exec, exec, 16
  v_add_f32 v208, v144, v146
  v_add_f32 v209, v145, v147
  s_lshl_b64 exec, exec, 16
  v_add_f32 v208, v148, v150
  v_add_f32 v209, v149, v151
  s_lshl_b64 exec, exec, 16
  v_add_f32 v208, v152, v154
  v_add_f32 v209, v153, v155
  s_mov_b64 exec, -1
  ds_write_b96 v217, v[208:210]
  ds_write_b32 v216, v213 offset:16
L_end:
  s_endpgm
L_hotend:
L_far:
  s_waitcnt vmcnt(0)
  global_load_dword v20, v21, s[14:15] sc1
  s_waitcnt vmcnt(0)
  v_readfirstlane_b32 s38, v20
  s_nop 0
  s_and_b32 s37, s38, 0x1f1f1f1f
  s_cmp_eq_u32 s37, s39
  s_cselect_b32 s48, -1, 0
  s_cbranch_scc0 L_far2
  global_load_dwordx3 v[176:178], v25, s[16:17] offset:0 sc1
  global_load_dwordx3 v[180:182], v26, s[16:17] offset:0 sc1
  global_load_dwordx3 v[184:186], v27, s[16:17] offset:0 sc1
  s_branch L_fin
L_far2:
  global_store_dwordx3 v24, v[64:66], s[16:17] offset:1024 sc1
  s_lshl_b32 s36, s19, 3
  s_lshl_b32 s36, 32, s36
  v_mov_b32 v22, s36
  s_waitcnt vmcnt(0)
  s_mov_b64 exec, 1
  global_atomic_or v20, v21, v22, s[14:15] sc0 sc1
  s_mov_b64 exec, -1
  s_waitcnt vmcnt(0)
  v_readfirstlane_b32 s37, v20
  s_nop 0
  s_or_b32 s37, s37, s36
  s_andn2_b32 s37, 0x20202020, s37
  s_cbranch_scc1 L_end
  global_load_dwordx3 v[176:178], v25, s[16:17] offset:1024 sc1
  global_load_dwordx3 v[180:182], v26, s[16:17] offset:1024 sc1
  global_load_dwordx3 v[184:186], v27, s[16:17] offset:1024 sc1
  s_mov_b32 s48, -1
  s_branch L_fin
.section .rodata,"a"
.p2align 6
.amdhsa_kernel standalone__linear_kernel_rfa__decode_kernel
  .amdhsa_next_free_vgpr 240
  .amdhsa_next_free_sgpr 96
  .amdhsa_accum_offset 240
  .amdhsa_group_segment_fixed_size 0
  .amdhsa_kernarg_size 56
  .amdhsa_user_sgpr_count 2
  .amdhsa_user_sgpr_kernarg_segment_ptr 1
  .amdhsa_system_sgpr_workgroup_id_x 1
.end_amdhsa_kernel
```
